```python
import torch

def _softmax(x, axis=-1):
    return torch.softmax(x, dim=axis)
def _gelu(x):
    return torch.nn.functional.gelu(x, approximate="tanh")
def _silu(x):
    return torch.nn.functional.silu(x)
def _sigmoid(x):
    return torch.sigmoid(x)
def _layernorm(x, axis=-1, eps=1e-5):
    m = x.mean(dim=axis, keepdim=True)
    v = x.var(dim=axis, keepdim=True, unbiased=False)
    return (x - m) / torch.sqrt(v + eps)
def _scatter_add(tgt, idx, src, axis=0):
    return tgt.clone().index_add_(axis, idx, src)
def _segment_sum(src, seg, n):
    out = torch.zeros((n,) + src.shape[1:], dtype=src.dtype)
    return out.index_add_(0, seg, src)
def _pad(x, pw):
    flat = tuple(v for pair in reversed(pw) for v in pair)
    return torch.nn.functional.pad(x, flat)

kernel_name = 'sequential_preLN__grouped_kv_mqa__moe_arch_mod__prompt'

def setup_inputs():

    _w = (lambda a: (lambda t: t.to(torch.bfloat16) if t.is_floating_point() else t)(torch.as_tensor(a)))
    def _A_setup():
        B, S, D, H = 1, 2048, 512, 32
        Dh = D // H
        return {
            "x": _w((lambda *s: torch.randn(*s, dtype=torch.bfloat16) * 0.05)(B, S, D)),
            "wq": _w((lambda *s: torch.randn(*s, dtype=torch.bfloat16) * 0.2)(D, H * Dh)),
            "wk": _w((lambda *s: torch.randn(*s, dtype=torch.bfloat16) * 0.2)(D, Dh)),
            "wv": _w((lambda *s: torch.randn(*s, dtype=torch.bfloat16) * 0.2)(D, Dh)),
            "wo": _w((lambda *s: torch.randn(*s, dtype=torch.bfloat16) * 0.2)(H * Dh, D)),
        }
    _A_in = _A_setup()

    def _B_setup():
        B, S, D, F, C = 1, 2048, 512, 1792, 2
        return {
            "x": _w((lambda *s: torch.randn(*s, dtype=torch.bfloat16) * 0.05)(B, S, D)),
            "w_r": _w((lambda *s: torch.randn(*s, dtype=torch.bfloat16) * 0.2)(D)),
            "w_gate": _w((lambda *s: torch.randn(*s, dtype=torch.bfloat16) * 0.2)(D, F)),
            "w_up": _w((lambda *s: torch.randn(*s, dtype=torch.bfloat16) * 0.2)(D, F)),
            "w_down": _w((lambda *s: torch.randn(*s, dtype=torch.bfloat16) * 0.2)(F, D)),
        }
    _B_in = _B_setup()

    return {
        "A_x": _A_in["x"],
        "A_wq": _A_in["wq"],
        "A_wk": _A_in["wk"],
        "A_wv": _A_in["wv"],
        "A_wo": _A_in["wo"],
        "B_x": _B_in["x"],
        "B_w_r": _B_in["w_r"],
        "B_w_gate": _B_in["w_gate"],
        "B_w_up": _B_in["w_up"],
        "B_w_down": _B_in["w_down"],
    }

def reference(A_x, A_wq, A_wk, A_wv, A_wo, B_x, B_w_r, B_w_gate, B_w_up, B_w_down):
    def _A_ref(x, wq, wk, wv, wo):
        B, S, D = x.shape
        H = 32
        Dh = D // H
        q = (lambda x, *d: x.permute(*d))((x @ wq).reshape(B, S, H, Dh), 0, 2, 1, 3)
        k = x @ wk
        v = x @ wv
        scores = torch.einsum("bhqd,bkd->bhqk", q, k) * (Dh ** -0.5)
        p = _softmax(scores, axis=-1)
        o = torch.einsum("bhqk,bkd->bhqd", p, v)
        return (lambda x, *d: x.permute(*d))(o, 0, 2, 1, 3).reshape(B, S, H * Dh) @ wo

    def _B_ref(x, w_r, w_gate, w_up, w_down):
        B, S, D = x.shape
        C = 2
        r = x @ w_r
        idx = torch.argsort(-r, axis=-1)[:, :C]
        idx_e = (lambda x, n, axis: torch.repeat_interleave(x, n, dim=axis))(idx.reshape(B, C, 1), D, axis=2)
        x_sel = (lambda x, i, axis: torch.take_along_dim(x, i, dim=axis))(x, idx_e, axis=1)
        g = _silu(x_sel @ w_gate)
        u = x_sel @ w_up
        y = (g * u) @ w_down
        r_sel = _sigmoid((lambda x, i, axis: torch.take_along_dim(x, i, dim=axis))(r, idx, axis=1))
        y = y * r_sel.reshape(B, C, 1)
        b_off = (torch.arange(B) * S).reshape(B, 1)
        flat_idx = (idx + b_off).reshape(B * C)
        zero = (x * 0.0).reshape(B * S, D)
        upd = _scatter_add(zero, flat_idx, y.reshape(B * C, D), axis=0)
        return x + upd.reshape(B, S, D)

    x = A_x
    h = x + _A_ref(_layernorm(x, axis=-1), A_wq, A_wk, A_wv, A_wo)
    h2 = h + _B_ref(_layernorm(h, axis=-1), B_w_r, B_w_gate, B_w_up, B_w_down)
    return h2
```

```asm
; @launch grid=(256,1,1) block=(512,1,1) lds=163840
.amdgcn_target "amdgcn-amd-amdhsa--gfx950"
.text
.globl sequential_preLN__grouped_kv_mqa__moe_arch_mod__prompt_kernel
.p2align 8
.type sequential_preLN__grouped_kv_mqa__moe_arch_mod__prompt_kernel,@function
sequential_preLN__grouped_kv_mqa__moe_arch_mod__prompt_kernel:
    s_cmp_ge_u32 s2, 256
    s_cbranch_scc1 L_END
    s_load_dwordx8 s[4:11], s[0:1], 0
    s_load_dwordx2 s[72:73], s[0:1], 96
    s_load_dwordx4 s[68:71], s[0:1], 80
    s_load_dwordx2 s[12:13], s[0:1], 32
    s_load_dwordx8 s[60:67], s[0:1], 48
    v_lshrrev_b32 v1, 6, v0
    s_and_b32 s37, s2, 7
    v_readfirstlane_b32 s36, v1
    s_getpc_b64 s[58:59]
L_PC:
    s_lshr_b32 s39, s2, 5
    s_xor_b32 s39, s39, 1
    s_lshr_b32 s38, s36, 1
    s_or_b32 s39, s39, s38
    s_cbranch_scc1 L_NOPF
    v_lshlrev_b32 v4, 7, v0
    v_min_u32 v4, L_CODE_END-L_PC-4, v4
    global_load_dword v5, v4, s[58:59]
L_NOPF:
    s_lshl_b32 s37, s37, 2
    s_bfe_u32 s39, s2, 0x20003
    s_add_u32 s37, s37, s39
    s_lshr_b32 s38, s2, 5
    v_and_b32 v1, 63, v0
    v_lshlrev_b32 v2, 4, v1
    s_lshl_b32 s41, s37, 16
    v_mov_b32 v10, 155904
    s_mov_b32 s18, 2097152
    s_mov_b32 s19, 0x00020000
    s_mov_b32 s23, 0x00020000
    s_cmp_ge_u32 s36, 4
    s_cbranch_scc1 L_HELP
    v_and_b32 v12, 15, v1
    s_lshr_b32 s45, s38, 1
    s_lshl_b32 s45, s45, 14
    s_lshl_b32 s46, s36, 8
    s_add_u32 s45, s45, s46
    s_add_u32 s45, s45, s41
    v_and_b32 v14, 48, v1
    v_lshl_add_u32 v12, v12, 10, v14
    s_lshl_b32 s46, s36, 12
    s_add_u32 s47, s46, 131072
    s_mov_b32 m0, s47
    s_movk_i32 s22, 16384
    s_bitcmp1_b32 s38, 0
    s_waitcnt lgkmcnt(0)
    s_cselect_b32 s20, s10, s8
    s_cselect_b32 s21, s11, s9
    s_mov_b32 s16, s4
    s_mov_b32 s17, s5
    buffer_load_dwordx4 v[64:67], v12, s[16:19], s45 offen offset:0
    buffer_load_dwordx4 v2, s[20:23], s46 offen offset:0 lds
    buffer_load_dwordx4 v[68:71], v12, s[16:19], s45 offen offset:64
    buffer_load_dwordx4 v2, s[20:23], s46 offen offset:1024 lds
    buffer_load_dwordx4 v[72:75], v12, s[16:19], s45 offen offset:128
    buffer_load_dwordx4 v2, s[20:23], s46 offen offset:2048 lds
    buffer_load_dwordx4 v[76:79], v12, s[16:19], s45 offen offset:192
    buffer_load_dwordx4 v2, s[20:23], s46 offen offset:3072 lds
    s_barrier
    s_branch L_COMP
L_HELP:
    v_mov_b32 v16, 0
    v_mov_b32 v17, 0
    v_mov_b32 v18, 0
    v_mov_b32 v19, 0
    ds_write_b128 v10, v[16:19]
    ds_write_b128 v10, v[16:19] offset:4048
    s_cmp_ge_u32 s36, 6
    s_cbranch_scc1 L_H67
    v_lshrrev_b32 v12, 3, v1
    v_and_b32 v13, 7, v1
    v_lshrrev_b32 v14, 1, v12
    s_lshl_b32 s27, s37, 1
    s_add_u32 s27, s27, s38
    s_mov_b32 s33, 0
    s_cmp_eq_u32 s36, 4
    s_cbranch_scc1 L_IS0
    v_and_b32 v14, 1, v14
    v_lshlrev_b32 v14, 2, v14
    v_add_u32 v10, 4, v10
L_IS0:
    v_xor_b32 v15, v14, v13
    v_lshlrev_b32 v15, 4, v15
    v_lshl_add_u32 v132, v12, 10, v15
    s_cselect_b32 s39, 64, 0
    v_xor_b32 v133, s39, v132
    v_add_u32 v133, 8192, v133
    v_mov_b32 v12, 1
    s_cselect_b32 s22, s18, 524288
    s_cselect_b32 s25, 7, 16
    s_cselect_b32 s26, 0, 65536
    s_waitcnt lgkmcnt(0)
    s_cselect_b32 s20, s4, s6
    s_cselect_b32 s21, s5, s7
    s_cselect_b32 s24, s41, 0
    s_cselect_b32 s39, 0, s38
    s_lshl_b32 s39, s39, 7
    s_add_u32 s24, s24, s39
    s_barrier
    s_call_b64 s[34:35], L_IS2
    s_call_b64 s[34:35], L_IS2
    s_call_b64 s[34:35], L_IS2
    s_call_b64 s[58:59], L_SETUP
L_ISL:
    s_waitcnt vmcnt(16)
    ds_write_b32 v10, v12
    v_add_u32 v12, 1, v12
    s_call_b64 s[34:35], L_IS2
    s_cmp_lt_u32 s33, 8
    s_cbranch_scc1 L_ISL
    s_branch L_XTRA
L_IS2:
    s_add_u32 s32, s27, s33
    s_and_b32 s32, s32, 7
    s_lshl_b32 s32, s32, s25
    s_add_u32 s32, s32, s24
    s_mov_b32 m0, s26
    s_nop 0
    buffer_load_dwordx4 v132, s[20:23], s32 offen lds
    s_addk_i32 m0, 1024
    s_nop 0
    buffer_load_dwordx4 v133, s[20:23], s32 offen lds
    s_addk_i32 m0, 1024
    s_addk_i32 s32, 16384
    s_nop 0
    buffer_load_dwordx4 v132, s[20:23], s32 offen lds
    s_addk_i32 m0, 1024
    s_nop 0
    buffer_load_dwordx4 v133, s[20:23], s32 offen lds
    s_addk_i32 m0, 1024
    s_addk_i32 s32, 16384
    s_nop 0
    buffer_load_dwordx4 v132, s[20:23], s32 offen lds
    s_addk_i32 m0, 1024
    s_nop 0
    buffer_load_dwordx4 v133, s[20:23], s32 offen lds
    s_addk_i32 m0, 1024
    s_addk_i32 s32, 16384
    s_nop 0
    buffer_load_dwordx4 v132, s[20:23], s32 offen lds
    s_addk_i32 m0, 1024
    s_nop 0
    buffer_load_dwordx4 v133, s[20:23], s32 offen lds
    s_addk_i32 m0, 1024
    s_addk_i32 s32, 16384
    s_addk_i32 s26, 8192
    s_add_u32 s33, s33, 1
    s_setpc_b64 s[34:35]
L_H67:
    s_mov_b32 s30, 5136384
    s_mov_b32 s31, 0x00020000
    s_lshr_b32 s39, s2, 3
    s_xor_b32 s46, s36, 7
    s_or_b32 s39, s39, s46
    s_waitcnt lgkmcnt(0)
    s_mov_b32 s28, s72
    s_mov_b32 s29, s73
    s_cbranch_scc1 L_H6
    v_mov_b32 v24, -1
    v_mov_b32 v25, -1
    v_mov_b32 v26, -1
    v_mov_b32 v27, -1
    s_lshl_b32 s39, s2, 12
    buffer_store_dwordx4 v[24:27], v2, s[28:31], s39 offen offset:0 sc1
    buffer_store_dwordx4 v[24:27], v2, s[28:31], s39 offen offset:1024 sc1
    buffer_store_dwordx4 v[24:27], v2, s[28:31], s39 offen offset:2048 sc1
    buffer_store_dwordx4 v[24:27], v2, s[28:31], s39 offen offset:3072 sc1
    s_lshl_b32 s39, s2, 11
    s_add_u32 s39, s39, 131072
    buffer_store_dwordx4 v[24:27], v2, s[28:31], s39 offen offset:0 sc1
    buffer_store_dwordx4 v[24:27], v2, s[28:31], s39 offen offset:1024 sc1
    s_lshl_b32 s39, s2, 10
    s_add_u32 s39, s39, 4931584
    buffer_store_dwordx4 v[16:19], v2, s[28:31], s39 offen sc1
L_H6:
    s_barrier
    s_cmp_eq_u32 s36, 6
    s_cbranch_scc1 L_FIN
    s_branch L_W7
L_SETUP:
    s_and_b32 s49, s36, 1
    s_bfe_u32 s50, s36, 0x10001
    s_lshr_b32 s51, s36, 2
    s_mov_b32 s28, s72
    s_mov_b32 s29, s73
    s_mov_b32 s30, 5136384
    s_mov_b32 s31, 0x00020000
    s_and_b32 s48, s36, 3
    s_lshl_b32 s47, s48, 11
    v_add_u32 v24, s47, v2
    s_movk_i32 s43, 16384
    v_and_b32 v27, 31, v1
    v_lshlrev_b32 v25, 3, v27
    s_lshl_b32 s45, s37, 9
    s_lshl_b32 s46, s49, 8
    s_add_u32 s45, s45, s46
    s_add_u32 s45, s45, 131072
    v_lshrrev_b32 v26, 5, v1
    s_lshl_b32 s52, s50, 1
    s_add_u32 s52, s52, s51
    s_lshl_b32 s46, s48, 6
    s_add_u32 s46, s46, 156160
    v_lshl_add_u32 v9, v26, 5, s46
    s_and_b32 s46, s36, 3
    s_lshl_b32 s46, s46, 12
    s_add_u32 s46, s46, 133120
    v_lshl_add_u32 v11, v1, 5, s46
    s_mov_b32 s16, s4
    s_mov_b32 s17, s5
    s_lshl_b32 s53, s37, 3
    s_add_u32 s53, s53, s38
    s_lshl_b32 s54, s53, 3
    s_add_u32 s54, s54, s36
    s_lshl_b32 s55, s54, 10
    s_lshl_b32 s56, s49, 15
    s_add_u32 s56, s56, s41
    s_lshl_b32 s39, s38, 11
    s_add_u32 s56, s56, s39
    s_lshl_b32 s39, s52, 9
    s_add_u32 s56, s56, s39
    s_add_u32 s56, s56, 671744
    s_and_b32 s42, s38, 1
    s_lshl_b32 s42, s42, 3
    s_add_u32 s57, s42, s36
    s_lshl_b32 s42, s57, 15
    s_add_u32 s42, s42, 147456
    v_bfe_u32 v14, v1, 4, 1
    v_lshlrev_b32 v3, 14, v14
    v_lshl_add_u32 v3, v26, 8, v3
    v_and_b32 v14, 15, v1
    v_lshl_add_u32 v3, v14, 4, v3
    s_mul_i32 s47, s48, 2064
    v_add_u32 v30, s47, v2
    v_and_b32 v14, 15, v1
    v_mul_u32_u24 v28, 8256, v14
    s_add_u32 s48, s47, 2048
    v_add_u32 v28, s48, v28
    v_mov_b32 v16, 0x3f803f80
    v_mov_b32 v17, 0x3f803f80
    v_mov_b32 v18, 0x3f803f80
    v_mov_b32 v19, 0x3f803f80
    v_lshlrev_b32 v26, 8, v26
    v_lshl_add_u32 v26, v27, 4, v26
    v_add_u32 v26, 1024, v26
    v_add_u32 v23, 512, v26
    v_mov_b32 v29, 2048
    v_mov_b32 v31, 0x100000
    v_cmp_eq_u32 vcc, 16, v27
    v_mov_b32 v20, 0xdddddddd
    v_mov_b32 v21, v2
    v_cndmask_b32 v29, v31, v29, vcc
    v_cmp_gt_u32 vcc, 16, v27
    s_nop 1
    v_cndmask_b32 v22, v29, v26, vcc
    v_cndmask_b32 v23, v29, v23, vcc
    s_setpc_b64 s[58:59]
L_COMP:
    s_and_b32 s49, s36, 1
    s_bfe_u32 s50, s36, 0x10001
    s_mov_b32 s40, 0x3f803f80
    v_lshrrev_b32 v13, 4, v1
    v_bfe_u32 v14, v1, 2, 2
    v_lshl_add_u32 v12, v13, 3, v14
    v_and_b32 v15, 3, v1
    v_lshlrev_b32 v15, 3, v15
    v_lshl_add_u32 v12, v12, 5, v15
    v_add_u32 v114, s47, v12
    v_and_b32 v12, 31, v1
    s_lshl_b32 s39, s49, 5
    v_add_u32 v12, s39, v12
    v_bfe_u32 v13, v12, 1, 3
    v_lshrrev_b32 v15, 5, v1
    v_xor_b32 v13, v13, v15
    v_lshlrev_b32 v13, 4, v13
    v_lshlrev_b32 v12, 7, v12
    v_add_u32 v4, v12, v13
    v_xor_b32 v6, 64, v4
    v_xor_b32 v7, 0x60, v4
    v_lshl_add_u32 v13, v15, 3, v14
    v_lshrrev_b32 v14, 1, v14
    v_lshlrev_b32 v14, 2, v14
    v_bfe_u32 v15, v1, 4, 1
    v_lshlrev_b32 v15, 1, v15
    v_bfe_u32 v8, v1, 1, 1
    v_add_u32 v15, v15, v8
    s_lshl_b32 s48, s50, 2
    v_add_u32 v15, s48, v15
    v_xor_b32 v15, v15, v14
    v_lshlrev_b32 v15, 4, v15
    v_lshl_add_u32 v8, v13, 7, v15
    v_and_b32 v15, 1, v1
    v_lshl_add_u32 v8, v15, 3, v8
    v_add_u32 v8, 65536, v8
    s_lshl_b32 s46, s36, 10
    s_add_u32 s46, s46, 147456
    v_add_u32 v12, s46, v2
    s_lshl_b32 s46, s36, 8
    s_add_u32 s46, s46, 151552
    v_lshl_add_u32 v116, v1, 2, s46
    v_mov_b32 v115, 1
    s_call_b64 s[58:59], L_SETUP
    v_mov_b32 v144, 0
    v_mov_b32 v145, 0
    v_mov_b32 v146, 0
    v_mov_b32 v147, 0
    v_mov_b32 v148, 0
    v_mov_b32 v149, 0
    v_mov_b32 v150, 0
    v_mov_b32 v151, 0
    v_mov_b32 v152, 0
    v_mov_b32 v153, 0
    v_mov_b32 v154, 0
    v_mov_b32 v155, 0
    v_mov_b32 v156, 0
    v_mov_b32 v157, 0
    v_mov_b32 v158, 0
    v_mov_b32 v159, 0
    v_mov_b32 v160, 0
    v_mov_b32 v161, 0
    v_mov_b32 v162, 0
    v_mov_b32 v163, 0
    v_mov_b32 v164, 0
    v_mov_b32 v165, 0
    v_mov_b32 v166, 0
    v_mov_b32 v167, 0
    v_mov_b32 v168, 0
    v_mov_b32 v169, 0
    v_mov_b32 v170, 0
    v_mov_b32 v171, 0
    v_mov_b32 v172, 0
    v_mov_b32 v173, 0
    v_mov_b32 v174, 0
    v_mov_b32 v175, 0
    v_mov_b32 v176, s40
    v_mov_b32 v177, s40
    v_mov_b32 v178, s40
    v_mov_b32 v179, s40
    v_mov_b32 v96, 0
    v_mov_b32 v97, 0
    v_mov_b32 v98, 0
    v_mov_b32 v99, 0
    v_mov_b32 v100, 0
    v_mov_b32 v101, 0
    v_mov_b32 v102, 0
    v_mov_b32 v103, 0
    s_waitcnt vmcnt(0)
    v_xor_b32 v5, 32, v4
    ds_read_b64_tr_b16 v[80:81], v114 offset:0
    ds_read_b64_tr_b16 v[82:83], v114 offset:128
    ds_read_b64_tr_b16 v[84:85], v114 offset:1024
    ds_read_b64_tr_b16 v[86:87], v114 offset:1152
    ds_read_b64_tr_b16 v[88:89], v114 offset:2048
    ds_read_b64_tr_b16 v[90:91], v114 offset:2176
    ds_read_b64_tr_b16 v[92:93], v114 offset:3072
    ds_read_b64_tr_b16 v[94:95], v114 offset:3200
    v_dot2c_f32_bf16 v100, s40, v64
    v_dot2c_f32_bf16 v101, v64, v64
    v_dot2c_f32_bf16 v100, s40, v65
    v_dot2c_f32_bf16 v101, v65, v65
    v_dot2c_f32_bf16 v100, s40, v66
    v_dot2c_f32_bf16 v101, v66, v66
    v_dot2c_f32_bf16 v100, s40, v67
    v_dot2c_f32_bf16 v101, v67, v67
    v_dot2c_f32_bf16 v100, s40, v68
    v_dot2c_f32_bf16 v101, v68, v68
    v_dot2c_f32_bf16 v100, s40, v69
    v_dot2c_f32_bf16 v101, v69, v69
    v_dot2c_f32_bf16 v100, s40, v70
    v_dot2c_f32_bf16 v101, v70, v70
    v_dot2c_f32_bf16 v100, s40, v71
    v_dot2c_f32_bf16 v101, v71, v71
    v_dot2c_f32_bf16 v100, s40, v72
    v_dot2c_f32_bf16 v101, v72, v72
    v_dot2c_f32_bf16 v100, s40, v73
    v_dot2c_f32_bf16 v101, v73, v73
    v_dot2c_f32_bf16 v100, s40, v74
    v_dot2c_f32_bf16 v101, v74, v74
    v_dot2c_f32_bf16 v100, s40, v75
    v_dot2c_f32_bf16 v101, v75, v75
    v_dot2c_f32_bf16 v100, s40, v76
    v_dot2c_f32_bf16 v101, v76, v76
    v_dot2c_f32_bf16 v100, s40, v77
    v_dot2c_f32_bf16 v101, v77, v77
    v_dot2c_f32_bf16 v100, s40, v78
    v_dot2c_f32_bf16 v101, v78, v78
    v_dot2c_f32_bf16 v100, s40, v79
    v_dot2c_f32_bf16 v101, v79, v79
    s_waitcnt lgkmcnt(0)
    s_bitcmp1_b32 s38, 0
    s_cbranch_scc1 L_VM
    v_mfma_f32_16x16x32_bf16 v[96:99], v[80:83], v[64:67], v[96:99]
    v_mfma_f32_16x16x32_bf16 v[96:99], v[84:87], v[68:71], v[96:99]
    v_mfma_f32_16x16x32_bf16 v[96:99], v[88:91], v[72:75], v[96:99]
    v_mfma_f32_16x16x32_bf16 v[96:99], v[92:95], v[76:79], v[96:99]
    s_branch L_KM
L_VM:
    v_mfma_f32_16x16x32_bf16 v[96:99], v[64:67], v[80:83], v[96:99]
    v_mfma_f32_16x16x32_bf16 v[96:99], v[68:71], v[84:87], v[96:99]
    v_mfma_f32_16x16x32_bf16 v[96:99], v[72:75], v[88:91], v[96:99]
    v_mfma_f32_16x16x32_bf16 v[96:99], v[76:79], v[92:95], v[96:99]
L_KM:
    v_dot2c_f32_bf16 v102, s40, v80
    v_dot2c_f32_bf16 v103, s40, v81
    v_dot2c_f32_bf16 v102, s40, v82
    v_dot2c_f32_bf16 v103, s40, v83
    v_dot2c_f32_bf16 v102, s40, v84
    v_dot2c_f32_bf16 v103, s40, v85
    v_dot2c_f32_bf16 v102, s40, v86
    v_dot2c_f32_bf16 v103, s40, v87
    v_dot2c_f32_bf16 v102, s40, v88
    v_dot2c_f32_bf16 v103, s40, v89
    v_dot2c_f32_bf16 v102, s40, v90
    v_dot2c_f32_bf16 v103, s40, v91
    v_dot2c_f32_bf16 v102, s40, v92
    v_dot2c_f32_bf16 v103, s40, v93
    v_dot2c_f32_bf16 v102, s40, v94
    v_dot2c_f32_bf16 v103, s40, v95
    ds_write_b128 v12, v[96:99]
    v_permlane16_swap_b32 v100, v101
    v_add_f32 v100, v100, v101
    v_add_f32 v102, v102, v103
    v_mov_b32 v103, 0
    s_nop 1
    v_permlane16_swap_b32 v102, v103
    v_add_f32 v102, v102, v103
    s_nop 1
    v_permlane32_swap_b32 v100, v102
    v_add_f32 v100, v100, v102
    ds_write_b32 v116, v100
    s_mov_b64 exec, 1
    ds_add_u32 v10, v115 offset:12
    s_mov_b64 exec, -1
    s_mov_b32 s57, 0
    s_mov_b32 s58, 0
    s_mov_b32 s39, 2000000
    s_cmp_lt_u32 s57, s58
    s_cbranch_scc1 L_QGOP
L_QWAITP:
    ds_read_b64 v[12:13], v10
    s_sub_u32 s39, s39, 1
    s_cbranch_scc1 L_QGOP
    s_waitcnt lgkmcnt(0)
    v_min_u32 v12, v12, v13
    s_nop 0
    v_readfirstlane_b32 s58, v12
    s_cmp_lt_u32 s57, s58
    s_cbranch_scc0 L_QWAITP
L_QGOP:
    s_add_u32 s57, s57, 1
    ds_read_b128 v[32:35], v4 offset:0
    ds_read_b64_tr_b16 v[48:49], v8 offset:0
    ds_read_b64_tr_b16 v[50:51], v8 offset:512
    ds_read_b128 v[36:39], v5 offset:0
    ds_read_b64_tr_b16 v[52:53], v8 offset:2048
    ds_read_b64_tr_b16 v[54:55], v8 offset:2560
    ds_read_b128 v[40:43], v6 offset:0
    ds_read_b64_tr_b16 v[56:57], v8 offset:4096
    ds_read_b64_tr_b16 v[58:59], v8 offset:4608
    ds_read_b128 v[44:47], v7 offset:0
    ds_read_b64_tr_b16 v[60:61], v8 offset:6144
    ds_read_b64_tr_b16 v[62:63], v8 offset:6656
L_QLOOP:
    s_cmp_lt_u32 s57, s58
    s_cbranch_scc1 L_QGOA
L_QWAITA:
    ds_read_b64 v[12:13], v10
    s_sub_u32 s39, s39, 1
    s_cbranch_scc1 L_QGOA
    s_waitcnt lgkmcnt(0)
    v_min_u32 v12, v12, v13
    s_nop 0
    v_readfirstlane_b32 s58, v12
    s_cmp_lt_u32 s57, s58
    s_cbranch_scc0 L_QWAITA
L_QGOA:
    s_add_u32 s57, s57, 1
    s_waitcnt lgkmcnt(9)
    v_mfma_f32_32x32x16_bf16 v[144:159], v[48:51], v[32:35], v[144:159]
    v_mfma_f32_32x32x16_bf16 v[160:175], v[48:51], v[176:179], v[160:175]
    ds_read_b128 v[64:67], v4 offset:8192
    ds_read_b64_tr_b16 v[80:81], v8 offset:8192
    ds_read_b64_tr_b16 v[82:83], v8 offset:8704
    s_waitcnt lgkmcnt(9)
    v_mfma_f32_32x32x16_bf16 v[144:159], v[52:55], v[36:39], v[144:159]
    v_mfma_f32_32x32x16_bf16 v[160:175], v[52:55], v[176:179], v[160:175]
    ds_read_b128 v[68:71], v5 offset:8192
    ds_read_b64_tr_b16 v[84:85], v8 offset:10240
    ds_read_b64_tr_b16 v[86:87], v8 offset:10752
    s_waitcnt lgkmcnt(9)
    v_mfma_f32_32x32x16_bf16 v[144:159], v[56:59], v[40:43], v[144:159]
    v_mfma_f32_32x32x16_bf16 v[160:175], v[56:59], v[176:179], v[160:175]
    ds_read_b128 v[72:75], v6 offset:8192
    ds_read_b64_tr_b16 v[88:89], v8 offset:12288
    ds_read_b64_tr_b16 v[90:91], v8 offset:12800
    s_waitcnt lgkmcnt(9)
    v_mfma_f32_32x32x16_bf16 v[144:159], v[60:63], v[44:47], v[144:159]
    v_mfma_f32_32x32x16_bf16 v[160:175], v[60:63], v[176:179], v[160:175]
    ds_read_b128 v[76:79], v7 offset:8192
    ds_read_b64_tr_b16 v[92:93], v8 offset:14336
    ds_read_b64_tr_b16 v[94:95], v8 offset:14848
    v_add_u32 v4, 16384, v4
    v_add_u32 v5, 16384, v5
    v_add_u32 v6, 16384, v6
    v_add_u32 v7, 16384, v7
    v_add_u32 v8, 16384, v8
    s_cmp_eq_u32 s57, 8
    s_cbranch_scc1 L_QLAST
    s_cmp_lt_u32 s57, s58
    s_cbranch_scc1 L_QGOB
L_QWAITB:
    ds_read_b64 v[12:13], v10
    s_sub_u32 s39, s39, 1
    s_cbranch_scc1 L_QGOB
    s_waitcnt lgkmcnt(0)
    v_min_u32 v12, v12, v13
    s_nop 0
    v_readfirstlane_b32 s58, v12
    s_cmp_lt_u32 s57, s58
    s_cbranch_scc0 L_QWAITB
L_QGOB:
    s_add_u32 s57, s57, 1
    s_waitcnt lgkmcnt(9)
    v_mfma_f32_32x32x16_bf16 v[144:159], v[80:83], v[64:67], v[144:159]
    v_mfma_f32_32x32x16_bf16 v[160:175], v[80:83], v[176:179], v[160:175]
    ds_read_b128 v[32:35], v4 offset:0
    ds_read_b64_tr_b16 v[48:49], v8 offset:0
    ds_read_b64_tr_b16 v[50:51], v8 offset:512
    s_waitcnt lgkmcnt(9)
    v_mfma_f32_32x32x16_bf16 v[144:159], v[84:87], v[68:71], v[144:159]
    v_mfma_f32_32x32x16_bf16 v[160:175], v[84:87], v[176:179], v[160:175]
    ds_read_b128 v[36:39], v5 offset:0
    ds_read_b64_tr_b16 v[52:53], v8 offset:2048
    ds_read_b64_tr_b16 v[54:55], v8 offset:2560
    s_waitcnt lgkmcnt(9)
    v_mfma_f32_32x32x16_bf16 v[144:159], v[88:91], v[72:75], v[144:159]
    v_mfma_f32_32x32x16_bf16 v[160:175], v[88:91], v[176:179], v[160:175]
    ds_read_b128 v[40:43], v6 offset:0
    ds_read_b64_tr_b16 v[56:57], v8 offset:4096
    ds_read_b64_tr_b16 v[58:59], v8 offset:4608
    s_waitcnt lgkmcnt(9)
    v_mfma_f32_32x32x16_bf16 v[144:159], v[92:95], v[76:79], v[144:159]
    v_mfma_f32_32x32x16_bf16 v[160:175], v[92:95], v[176:179], v[160:175]
    ds_read_b128 v[44:47], v7 offset:0
    ds_read_b64_tr_b16 v[60:61], v8 offset:6144
    ds_read_b64_tr_b16 v[62:63], v8 offset:6656
    s_branch L_QLOOP
L_QLAST:
    s_setprio 2
    s_waitcnt lgkmcnt(0)
    v_mfma_f32_32x32x16_bf16 v[144:159], v[80:83], v[64:67], v[144:159]
    v_mfma_f32_32x32x16_bf16 v[160:175], v[80:83], v[176:179], v[160:175]
    v_mfma_f32_32x32x16_bf16 v[144:159], v[84:87], v[68:71], v[144:159]
    v_mfma_f32_32x32x16_bf16 v[160:175], v[84:87], v[176:179], v[160:175]
    v_mfma_f32_32x32x16_bf16 v[144:159], v[88:91], v[72:75], v[144:159]
    v_mfma_f32_32x32x16_bf16 v[160:175], v[88:91], v[176:179], v[160:175]
    v_mfma_f32_32x32x16_bf16 v[144:159], v[92:95], v[76:79], v[144:159]
    v_mfma_f32_32x32x16_bf16 v[160:175], v[92:95], v[176:179], v[160:175]
    s_nop 3
    s_barrier
    s_lshl_b32 s46, s36, 6
    s_add_u32 s46, s46, 156160
    v_add_u32 v13, s46, v1
    s_lshl_b32 s46, s36, 8
    s_add_u32 s46, s46, 160000
    v_add_u32 v24, s46, v25
    s_nop 1
    ds_write_b128 v11, v[152:155]
    ds_write_b128 v11, v[156:159] offset:16
    s_mov_b32 exec_lo, 1
    s_mov_b32 exec_hi, 1
    s_nop 0
    ds_write_b128 v13, v[168:171]
    ds_write_b128 v13, v[172:175] offset:16
    s_mov_b64 exec, -1
    s_branch L_JOIN2
L_FIN:
    s_call_b64 s[58:59], L_SETUP
    s_setprio 3
    v_mov_b32 v104, 1
    v_lshlrev_b32 v104, 7, v104
    v_add_u32 v12, 147456, v2
    v_and_b32 v13, 15, v1
    v_lshlrev_b32 v137, 3, v13
    v_lshlrev_b32 v14, 2, v13
    v_add_u32 v14, 151552, v14
    v_and_b32 v15, 48, v1
    v_add_u32 v15, 151552, v15
    s_lshl_b32 s40, s37, 1
    s_lshr_b32 s47, s38, 2
    s_add_u32 s40, s40, s47
    s_lshl_b32 s40, s40, 11
    s_bfe_u32 s47, s38, 0x10001
    s_lshl_b32 s44, s37, 9
    s_lshr_b32 s48, s38, 1
    s_lshl_b32 s48, s48, 7
    s_add_u32 s44, s44, s48
    s_add_u32 s44, s44, 131072
    v_bfe_u32 v64, v1, 4, 1
    v_lshrrev_b32 v65, 5, v1
    v_lshlrev_b32 v136, 4, v13
    s_bitcmp1_b32 s38, 0
    s_cbranch_scc1 L_FA1
    s_lshl_b32 s47, s47, 8
    v_lshl_add_u32 v136, v64, 9, v136
    v_lshl_add_u32 v136, v65, 3, v136
    s_branch L_FA2
L_FA1:
    s_lshl_b32 s47, s47, 9
    s_add_u32 s47, s47, 1024
    v_lshl_add_u32 v136, v64, 3, v136
    v_lshl_add_u32 v136, v65, 8, v136
    v_mov_b32 v137, 0x7ffffff0
L_FA2:
    s_add_u32 s40, s40, s47
    v_mov_b32 v105, 0
    v_mov_b32 v134, 0
    v_mov_b32 v135, 0
    s_mov_b32 s46, 0x3b000000
    s_mov_b32 s47, 0x3727c5ac
    s_mov_b32 s39, 2000000
L_KC_POLL:
    ds_read_b32 v13, v10 offset:12
    s_sub_u32 s39, s39, 1
    s_cbranch_scc1 L_KC_OUT
    s_waitcnt lgkmcnt(0)
    v_cmp_gt_u32 vcc, 4, v13
    s_cbranch_vccnz L_KC_POLL
L_KC_OUT:
    global_load_dword v105, v104, s[70:71] sc1
    s_mov_b32 s39, 20000
    s_bitcmp1_b32 s38, 0
    s_cbranch_scc1 L_FV
    ds_read2_b32 v[64:65], v14 offset0:0 offset1:16
    ds_read2_b32 v[66:67], v14 offset0:64 offset1:80
    ds_read2_b32 v[68:69], v14 offset0:128 offset1:144
    ds_read2_b32 v[70:71], v14 offset0:192 offset1:208
    ds_read_b128 v[72:75], v15 offset:128
    ds_read_b128 v[76:79], v15 offset:384
    ds_read_b128 v[80:83], v15 offset:640
    ds_read_b128 v[84:87], v15 offset:896
    ds_read_b128 v[88:91], v12 offset:0
    ds_read_b128 v[92:95], v12 offset:1024
    ds_read_b128 v[96:99], v12 offset:2048
    ds_read_b128 v[100:103], v12 offset:3072
    s_waitcnt lgkmcnt(8)
    v_pk_add_f32 v[64:65], v[64:65], v[66:67]
    v_pk_add_f32 v[68:69], v[68:69], v[70:71]
    v_pk_add_f32 v[64:65], v[64:65], v[68:69]
    v_mul_f32 v64, s46, v64
    v_mul_f32 v65, s46, v65
    v_fma_f32 v65, -v64, v64, v65
    v_add_f32 v65, s47, v65
    v_rsq_f32 v65, v65
    s_waitcnt lgkmcnt(4)
    v_pk_add_f32 v[72:73], v[72:73], v[76:77]
    v_pk_add_f32 v[80:81], v[80:81], v[84:85]
    v_pk_add_f32 v[74:75], v[74:75], v[78:79]
    v_pk_add_f32 v[82:83], v[82:83], v[86:87]
    v_pk_add_f32 v[72:73], v[72:73], v[80:81]
    v_pk_add_f32 v[74:75], v[74:75], v[82:83]
    s_waitcnt lgkmcnt(0)
    v_pk_add_f32 v[88:89], v[88:89], v[92:93]
    v_pk_add_f32 v[96:97], v[96:97], v[100:101]
    v_pk_add_f32 v[90:91], v[90:91], v[94:95]
    v_pk_add_f32 v[98:99], v[98:99], v[102:103]
    v_pk_add_f32 v[88:89], v[88:89], v[96:97]
    v_pk_add_f32 v[90:91], v[90:91], v[98:99]
    v_fma_f32 v88, -v64, v72, v88
    v_fma_f32 v89, -v64, v73, v89
    v_fma_f32 v90, -v64, v74, v90
    v_fma_f32 v91, -v64, v75, v91
    v_mul_f32 v88, v88, v65
    v_mul_f32 v89, v89, v65
    v_mul_f32 v90, v90, v65
    v_mul_f32 v91, v91, v65
    v_max3_f32 v66, abs(v88), abs(v89), abs(v90)
    v_cvt_pk_bf16_f32 v92, v88, v89
    v_max_f32 v66, v66, abs(v91)
    v_cvt_pk_bf16_f32 v93, v90, v91
    v_cmp_lt_f32 vcc, 0x477fe000, v66
    v_cvt_pk_f16_f32 v88, v88, v89
    v_cvt_pk_f16_f32 v89, v90, v91
    v_mov_b32 v67, 0x7e007e00
    v_min_u32 v134, -2, v64
    v_cndmask_b32 v88, v88, v67, vcc
    v_min_u32 v135, -2, v65
    s_add_u32 s48, s40, 5005312
    s_branch L_FS
L_FV:
    ds_read_b128 v[32:35], v15 offset:0
    ds_read_b128 v[36:39], v15 offset:64
    ds_read_b128 v[40:43], v15 offset:256
    ds_read_b128 v[44:47], v15 offset:320
    ds_read_b128 v[48:51], v15 offset:512
    ds_read_b128 v[52:55], v15 offset:576
    ds_read_b128 v[56:59], v15 offset:768
    ds_read_b128 v[60:63], v15 offset:832
    ds_read2_b32 v[64:65], v14 offset0:32 offset1:96
    ds_read2_b32 v[66:67], v14 offset0:160 offset1:224
    ds_read_b128 v[88:91], v12 offset:0
    ds_read_b128 v[92:95], v12 offset:1024
    ds_read_b128 v[96:99], v12 offset:2048
    ds_read_b128 v[100:103], v12 offset:3072
    s_waitcnt lgkmcnt(6)
    v_pk_add_f32 v[32:33], v[32:33], v[40:41]
    v_pk_add_f32 v[48:49], v[48:49], v[56:57]
    v_pk_add_f32 v[34:35], v[34:35], v[42:43]
    v_pk_add_f32 v[50:51], v[50:51], v[58:59]
    v_pk_add_f32 v[36:37], v[36:37], v[44:45]
    v_pk_add_f32 v[52:53], v[52:53], v[60:61]
    v_pk_add_f32 v[38:39], v[38:39], v[46:47]
    v_pk_add_f32 v[54:55], v[54:55], v[62:63]
    v_pk_add_f32 v[32:33], v[32:33], v[48:49]
    v_pk_add_f32 v[34:35], v[34:35], v[50:51]
    v_pk_add_f32 v[36:37], v[36:37], v[52:53]
    v_pk_add_f32 v[38:39], v[38:39], v[54:55]
    v_mul_f32 v32, s46, v32
    v_mul_f32 v33, s46, v33
    v_mul_f32 v34, s46, v34
    v_mul_f32 v35, s46, v35
    v_mul_f32 v36, s46, v36
    v_mul_f32 v37, s46, v37
    v_mul_f32 v38, s46, v38
    v_mul_f32 v39, s46, v39
    v_fma_f32 v36, -v32, v32, v36
    v_fma_f32 v37, -v33, v33, v37
    v_fma_f32 v38, -v34, v34, v38
    v_fma_f32 v39, -v35, v35, v39
    v_add_f32 v36, s47, v36
    v_add_f32 v37, s47, v37
    v_add_f32 v38, s47, v38
    v_add_f32 v39, s47, v39
    v_rsq_f32 v36, v36
    v_rsq_f32 v37, v37
    v_rsq_f32 v38, v38
    v_rsq_f32 v39, v39
    s_waitcnt lgkmcnt(0)
    v_pk_add_f32 v[64:65], v[64:65], v[66:67]
    v_pk_add_f32 v[88:89], v[88:89], v[92:93]
    v_pk_add_f32 v[96:97], v[96:97], v[100:101]
    v_pk_add_f32 v[90:91], v[90:91], v[94:95]
    v_pk_add_f32 v[98:99], v[98:99], v[102:103]
    v_pk_add_f32 v[88:89], v[88:89], v[96:97]
    v_pk_add_f32 v[90:91], v[90:91], v[98:99]
    v_add_f32 v64, v64, v65
    v_fma_f32 v88, -v32, v64, v88
    v_fma_f32 v89, -v33, v64, v89
    v_fma_f32 v90, -v34, v64, v90
    v_fma_f32 v91, -v35, v64, v91
    v_mul_f32 v88, v88, v36
    v_mul_f32 v89, v89, v37
    v_mul_f32 v90, v90, v38
    v_mul_f32 v91, v91, v39
    v_cvt_pk_bf16_f32 v88, v88, v89
    v_cvt_pk_bf16_f32 v89, v90, v91
    s_mov_b32 s48, 0x7ff00000
L_FS:
    v_min_u32 v132, -2, v88
    v_min_u32 v133, -2, v89
    buffer_store_dwordx2 v[132:133], v136, s[28:31], s40 offen sc1
    buffer_store_dwordx2 v[134:135], v137, s[28:31], s44 offen sc1
    buffer_store_dwordx2 v[92:93], v136, s[28:31], s48 offen sc1
    s_waitcnt vmcnt(3)
L_F0_POLL:
    v_cmp_ne_u32 vcc, 1, v105
    s_sub_u32 s39, s39, 1
    s_cbranch_scc1 L_KVS3
    s_cbranch_vccz L_KVS3
    s_sleep 0
    global_load_dword v105, v104, s[70:71] sc1
    s_waitcnt vmcnt(0)
    s_branch L_F0_POLL
L_KVS3:
    v_mov_b32 v13, 8
    ds_write_b32 v10, v13 offset:8
    s_waitcnt vmcnt(0)
    buffer_load_dwordx2 v[138:139], v136, s[28:31], s40 offen sc1
    buffer_load_dwordx2 v[140:141], v137, s[28:31], s44 offen sc1
    s_movk_i32 s46, 8192
    s_movk_i32 s47, 24576
    buffer_load_dwordx4 v[96:99], v24, s[28:31], 0 offen sc1
    buffer_load_dwordx4 v[108:111], v24, s[28:31], 0 offen offset:1024 sc1
    buffer_load_dwordx4 v[100:103], v24, s[28:31], s46 offen sc1
    buffer_load_dwordx4 v[112:115], v24, s[28:31], s46 offen offset:1024 sc1
    buffer_load_dwordx4 v[116:119], v24, s[28:31], s43 offen sc1
    buffer_load_dwordx4 v[120:123], v24, s[28:31], s43 offen offset:1024 sc1
    buffer_load_dwordx4 v[124:127], v24, s[28:31], s47 offen sc1
    buffer_load_dwordx4 v[128:131], v24, s[28:31], s47 offen offset:1024 sc1
    buffer_load_dwordx2 v[104:105], v25, s[28:31], s45 offen sc1
    s_waitcnt vmcnt(9)
    v_max3_u32 v138, v138, v139, v140
    v_max_u32 v138, v138, v141
    v_cmp_eq_u32 vcc, -1, v138
    s_cbranch_vccz L_SIG
    buffer_store_dwordx2 v[132:133], v136, s[28:31], s40 offen sc1
    buffer_store_dwordx2 v[134:135], v137, s[28:31], s44 offen sc1
    s_waitcnt vmcnt(0)
    s_branch L_SIG
L_W67:
    s_movk_i32 s46, 8192
    s_movk_i32 s47, 24576
    buffer_load_dwordx4 v[96:99], v24, s[28:31], 0 offen sc1
    buffer_load_dwordx4 v[108:111], v24, s[28:31], 0 offen offset:1024 sc1
    buffer_load_dwordx4 v[100:103], v24, s[28:31], s46 offen sc1
    buffer_load_dwordx4 v[112:115], v24, s[28:31], s46 offen offset:1024 sc1
    buffer_load_dwordx4 v[116:119], v24, s[28:31], s43 offen sc1
    buffer_load_dwordx4 v[120:123], v24, s[28:31], s43 offen offset:1024 sc1
    buffer_load_dwordx4 v[124:127], v24, s[28:31], s47 offen sc1
    buffer_load_dwordx4 v[128:131], v24, s[28:31], s47 offen offset:1024 sc1
    buffer_load_dwordx2 v[104:105], v25, s[28:31], s45 offen sc1
    s_waitcnt vmcnt(9)
L_SIG:
    s_lshr_b32 s46, s2, 2
    s_lshl_b32 s46, s46, 7
    s_add_u32 s46, s46, 4931584
    v_mov_b32 v12, s46
    v_mov_b32 v13, 1
    s_mov_b64 exec, 1
    global_atomic_add v12, v13, s[72:73] sc1
    s_mov_b64 exec, -1
    s_setprio 0
    s_branch L_KH_CHK
L_W7:
    s_mov_b32 s32, s12
    s_and_b32 s33, s13, 0xffff
    s_mov_b32 s34, 524288
    s_mov_b32 s35, 0x00020000
    s_and_b32 s46, s2, 15
    s_lshl_b32 s46, s46, 6
    s_lshr_b32 s47, s2, 4
    s_lshl_b32 s47, s47, 15
    s_add_u32 s46, s46, s47
    v_and_b32 v28, 3, v1
    v_lshlrev_b32 v28, 1, v28
    v_bfe_u32 v29, v1, 2, 2
    v_lshl_add_u32 v28, v29, 4, v28
    v_bfe_u32 v29, v1, 4, 1
    v_lshl_add_u32 v28, v29, 12, v28
    v_lshrrev_b32 v29, 5, v1
    v_lshl_add_u32 v28, v29, 14, v28
    s_add_u32 s47, s46, 0
    buffer_load_ushort v112, v28, s[32:35], s47 offen offset:0
    buffer_load_ushort v113, v28, s[32:35], s47 offen offset:1024
    buffer_load_ushort v114, v28, s[32:35], s47 offen offset:2048
    buffer_load_ushort v115, v28, s[32:35], s47 offen offset:3072
    s_add_u32 s47, s46, 8192
    buffer_load_ushort v116, v28, s[32:35], s47 offen offset:0
    buffer_load_ushort v117, v28, s[32:35], s47 offen offset:1024
    buffer_load_ushort v118, v28, s[32:35], s47 offen offset:2048
    buffer_load_ushort v119, v28, s[32:35], s47 offen offset:3072
    s_add_u32 s47, s46, 8
    buffer_load_ushort v120, v28, s[32:35], s47 offen offset:0
    buffer_load_ushort v121, v28, s[32:35], s47 offen offset:1024
    buffer_load_ushort v122, v28, s[32:35], s47 offen offset:2048
    buffer_load_ushort v123, v28, s[32:35], s47 offen offset:3072
    s_add_u32 s47, s46, 8200
    buffer_load_ushort v124, v28, s[32:35], s47 offen offset:0
    buffer_load_ushort v125, v28, s[32:35], s47 offen offset:1024
    buffer_load_ushort v126, v28, s[32:35], s47 offen offset:2048
    buffer_load_ushort v127, v28, s[32:35], s47 offen offset:3072
    s_cmp_lt_u32 s2, 8
    s_cbranch_scc0 L_W7B
    s_setprio 3
    v_mov_b32 v12, 1
    v_mov_b32 v13, 128
    s_mov_b64 exec, 1
    s_waitcnt vmcnt(16)
    global_atomic_add v14, v16, v12, s[70:71] sc0 sc1
    s_waitcnt vmcnt(0)
    v_readfirstlane_b32 s39, v14
    s_cmp_eq_u32 s39, 7
    s_cbranch_scc0 L_H7C
    global_store_dword v13, v12, s[70:71] sc1
L_H7C:
    s_mov_b64 exec, -1
    s_setprio 0
L_W7B:
    s_call_b64 s[58:59], L_SETUP
    s_waitcnt vmcnt(0)
    v_lshl_or_b32 v80, v113, 16, v112
    v_lshl_or_b32 v81, v115, 16, v114
    v_lshl_or_b32 v82, v117, 16, v116
    v_lshl_or_b32 v83, v119, 16, v118
    v_lshl_or_b32 v84, v121, 16, v120
    v_lshl_or_b32 v85, v123, 16, v122
    v_lshl_or_b32 v86, v125, 16, v124
    v_lshl_or_b32 v87, v127, 16, v126
    s_and_b32 s46, s2, 15
    s_lshl_b32 s46, s46, 15
    s_lshr_b32 s47, s2, 4
    s_lshl_b32 s47, s47, 11
    s_add_u32 s46, s46, s47
    s_add_u32 s46, s46, 147456
    buffer_store_dwordx4 v[80:83], v2, s[28:31], s46 offen sc1
    buffer_store_dwordx4 v[84:87], v2, s[28:31], s46 offen offset:1024 sc1
    s_mov_b32 s39, 2000000
L_W7W:
    s_sleep 2
    ds_read_b32 v12, v10 offset:8
    s_sub_u32 s39, s39, 1
    s_cbranch_scc1 L_W7G
    s_waitcnt lgkmcnt(0)
    v_cmp_eq_u32 vcc, 0, v12
    s_cbranch_vccnz L_W7W
L_W7G:
    s_branch L_W67
L_XTRA:
    v_mov_b32 v14, 155904
    ds_read_b32 v13, v14 offset:8
    s_waitcnt lgkmcnt(0)
    v_cmp_eq_u32 vcc, 0, v13
    s_cbranch_vccnz L_XLATE
    s_waitcnt vmcnt(16)
    ds_write_b32 v10, v12
    v_add_u32 v12, 1, v12
    s_movk_i32 s46, 8192
    s_movk_i32 s47, 24576
    buffer_load_dwordx4 v[96:99], v24, s[28:31], 0 offen sc1
    buffer_load_dwordx4 v[108:111], v24, s[28:31], 0 offen offset:1024 sc1
    buffer_load_dwordx4 v[100:103], v24, s[28:31], s46 offen sc1
    buffer_load_dwordx4 v[112:115], v24, s[28:31], s46 offen offset:1024 sc1
    buffer_load_dwordx4 v[116:119], v24, s[28:31], s43 offen sc1
    buffer_load_dwordx4 v[120:123], v24, s[28:31], s43 offen offset:1024 sc1
    buffer_load_dwordx4 v[124:127], v24, s[28:31], s47 offen sc1
    buffer_load_dwordx4 v[128:131], v24, s[28:31], s47 offen offset:1024 sc1
    buffer_load_dwordx2 v[104:105], v25, s[28:31], s45 offen sc1
    s_waitcnt vmcnt(17)
    ds_write_b32 v10, v12
    v_add_u32 v12, 1, v12
    s_waitcnt vmcnt(9)
    ds_write_b32 v10, v12
    v_add_u32 v12, 1, v12
    s_branch L_KH_CHK
L_XLATE:
    s_waitcnt vmcnt(16)
    ds_write_b32 v10, v12
    v_add_u32 v12, 1, v12
    s_waitcnt vmcnt(8)
    ds_write_b32 v10, v12
    v_add_u32 v12, 1, v12
    s_waitcnt vmcnt(0)
    ds_write_b32 v10, v12
    v_add_u32 v12, 1, v12
    v_mov_b32 v10, 155904
L_JOIN:
    s_mov_b32 s39, 2000000
L_HWAIT:
    s_sleep 2
    ds_read_b96 v[12:14], v10
    s_sub_u32 s39, s39, 1
    s_cbranch_scc1 L_HGO
    s_waitcnt lgkmcnt(0)
    v_min3_u32 v12, v12, v13, v14
    v_cmp_gt_u32 vcc, 7, v12
    s_cbranch_vccnz L_HWAIT
L_HGO:
    s_movk_i32 s46, 8192
    s_movk_i32 s47, 24576
    buffer_load_dwordx4 v[96:99], v24, s[28:31], 0 offen sc1
    buffer_load_dwordx4 v[108:111], v24, s[28:31], 0 offen offset:1024 sc1
    buffer_load_dwordx4 v[100:103], v24, s[28:31], s46 offen sc1
    buffer_load_dwordx4 v[112:115], v24, s[28:31], s46 offen offset:1024 sc1
    buffer_load_dwordx4 v[116:119], v24, s[28:31], s43 offen sc1
    buffer_load_dwordx4 v[120:123], v24, s[28:31], s43 offen offset:1024 sc1
    buffer_load_dwordx4 v[124:127], v24, s[28:31], s47 offen sc1
    buffer_load_dwordx4 v[128:131], v24, s[28:31], s47 offen offset:1024 sc1
    buffer_load_dwordx2 v[104:105], v25, s[28:31], s45 offen sc1
L_KH_CHK:
    v_mov_b32 v106, 0
    v_mov_b32 v107, 0
    s_mov_b32 s39, 20000
L_KH_POLL:
    s_waitcnt vmcnt(0)
    v_max3_u32 v29, v96, v97, v98
    v_max3_u32 v29, v29, v99, v100
    v_max3_u32 v29, v29, v101, v102
    v_max3_u32 v29, v29, v103, v104
    v_max3_u32 v29, v29, v105, v106
    v_max3_u32 v29, v29, v107, v108
    v_max3_u32 v29, v29, v109, v110
    v_max3_u32 v29, v29, v111, v112
    v_max3_u32 v29, v29, v113, v114
    v_max3_u32 v29, v29, v115, v116
    v_max3_u32 v29, v29, v117, v118
    v_max3_u32 v29, v29, v119, v120
    v_max3_u32 v29, v29, v121, v122
    v_max3_u32 v29, v29, v123, v124
    v_max3_u32 v29, v29, v125, v126
    v_max3_u32 v29, v29, v127, v128
    v_max3_u32 v29, v29, v129, v130
    v_max_u32 v29, v29, v131
    v_cmp_eq_u32 vcc, -1, v29
    s_sub_u32 s39, s39, 1
    s_cbranch_scc1 L_KH_OUT
    s_cbranch_vccz L_KH_OUT
    s_sleep 4
    s_movk_i32 s46, 8192
    s_movk_i32 s47, 24576
    buffer_load_dwordx4 v[96:99], v24, s[28:31], 0 offen sc1
    buffer_load_dwordx4 v[108:111], v24, s[28:31], 0 offen offset:1024 sc1
    buffer_load_dwordx4 v[100:103], v24, s[28:31], s46 offen sc1
    buffer_load_dwordx4 v[112:115], v24, s[28:31], s46 offen offset:1024 sc1
    buffer_load_dwordx4 v[116:119], v24, s[28:31], s43 offen sc1
    buffer_load_dwordx4 v[120:123], v24, s[28:31], s43 offen offset:1024 sc1
    buffer_load_dwordx4 v[124:127], v24, s[28:31], s47 offen sc1
    buffer_load_dwordx4 v[128:131], v24, s[28:31], s47 offen offset:1024 sc1
    buffer_load_dwordx2 v[104:105], v25, s[28:31], s45 offen sc1
    s_branch L_KH_POLL
L_KH_OUT:
    v_lshlrev_b32 v12, 7, v1
    v_add_u32 v15, 4931584, v12
    s_lshl_b32 s46, s36, 8
    s_add_u32 s46, s46, 158976
    v_add_u32 v24, s46, v25
    s_barrier
    global_load_dword v31, v15, s[72:73] sc1
    ds_write_b64 v24, v[104:105]
    ds_write_b128 v30, v[96:99]
    ds_write_b128 v30, v[108:111] offset:1024
    ds_write_b128 v28, v[16:19]
    ds_write_b128 v30, v[100:103] offset:8256
    ds_write_b128 v30, v[112:115] offset:9280
    s_waitcnt lgkmcnt(0)
    s_barrier
    ds_write_b128 v30, v[116:119] offset:16512
    ds_write_b128 v30, v[120:123] offset:17536
    ds_write_b128 v30, v[124:127] offset:24768
    ds_write_b128 v30, v[128:131] offset:25792
    v_mov_b32 v30, v15
    v_mov_b32 v28, 159952
    v_mov_b32 v29, 1
    s_mov_b64 exec, 1
    ds_add_u32 v28, v29 offset:12
    s_mov_b64 exec, -1
    ds_read_b128 v[144:147], v11
    ds_read_b128 v[148:151], v11 offset:16
    ds_read_b128 v[160:163], v9
    ds_read_b128 v[164:167], v9 offset:16
    s_branch L_LAG
L_JOIN2:
    s_waitcnt lgkmcnt(0)
    s_barrier
    ds_read_b64 v[104:105], v24
    ds_read_b128 v[96:99], v21 offset:4128
    ds_read_b128 v[100:103], v21 offset:2064
L_QFIN:
    ds_read_b128 v[8:11], v21
    ds_read_b128 v[16:19], v22
    s_waitcnt lgkmcnt(2)
    v_mul_f32 v105, 0x3eb8aa3b, v105
    v_fma_f32 v144, -v104, v160, v144
    v_fma_f32 v145, -v104, v161, v145
    v_fma_f32 v146, -v104, v162, v146
    v_fma_f32 v147, -v104, v163, v147
    v_fma_f32 v148, -v104, v164, v148
    v_fma_f32 v149, -v104, v165, v149
    v_fma_f32 v150, -v104, v166, v150
    v_fma_f32 v151, -v104, v167, v151
    v_pk_mul_f32 v[144:145], v[144:145], v[104:105] op_sel:[0,1] op_sel_hi:[1,1]
    v_pk_mul_f32 v[146:147], v[146:147], v[104:105] op_sel:[0,1] op_sel_hi:[1,1]
    v_pk_mul_f32 v[148:149], v[148:149], v[104:105] op_sel:[0,1] op_sel_hi:[1,1]
    v_pk_mul_f32 v[150:151], v[150:151], v[104:105] op_sel:[0,1] op_sel_hi:[1,1]
    s_nop 0
    v_max3_f32 v28, abs(v144), abs(v145), abs(v146)
    v_max3_f32 v29, abs(v147), abs(v148), abs(v149)
    v_max3_f32 v28, v28, abs(v150), abs(v151)
    v_max_f32 v28, v28, v29
    v_mov_b32 v29, 0x7e007e00
    v_cmp_lt_f32 vcc, 0x477fe000, v28
    v_cvt_pk_f16_f32 v4, v144, v145
    v_cvt_pk_f16_f32 v5, v146, v147
    v_cvt_pk_f16_f32 v6, v148, v149
    v_cvt_pk_f16_f32 v7, v150, v151
    v_cndmask_b32 v4, v4, v29, vcc
    v_mov_b32 v80, 0
    v_mov_b32 v81, 0
    v_mfma_f32_32x32x16_f16 v[48:63], v[96:99], v[4:7], 0
    v_mfma_f32_32x32x16_f16 v[64:79], v[100:103], v[4:7], 0
    v_mov_b32 v82, 0
    v_mov_b32 v83, 0
    v_mov_b32 v84, 0
    v_mov_b32 v85, 0
    v_mov_b32 v86, 0
    v_mov_b32 v87, 0
    v_mov_b32 v88, 0
    v_mov_b32 v89, 0
    v_mov_b32 v90, 0
    v_mov_b32 v91, 0
    v_cvt_pk_bf16_f32 v108, v144, v145
    v_cvt_pk_bf16_f32 v109, v146, v147
    v_cvt_pk_bf16_f32 v110, v148, v149
    v_cvt_pk_bf16_f32 v111, v150, v151
    v_max_f32 v28, v48, v49
    v_max3_f32 v28, v28, v50, v51
    v_max3_f32 v28, v28, v52, v53
    v_max3_f32 v28, v28, v54, v55
    v_max3_f32 v28, v28, v56, v57
    v_max3_f32 v28, v28, v58, v59
    v_max3_f32 v28, v28, v60, v61
    v_max3_f32 v28, v28, v62, v63
    v_max3_f32 v28, v28, v64, v65
    v_max3_f32 v28, v28, v66, v67
    v_max3_f32 v28, v28, v68, v69
    v_max3_f32 v28, v28, v70, v71
    v_max3_f32 v28, v28, v72, v73
    v_max3_f32 v28, v28, v74, v75
    v_max3_f32 v28, v28, v76, v77
    v_max3_f32 v28, v28, v78, v79
    v_mov_b32 v29, v28
    s_nop 1
    v_permlane32_swap_b32 v28, v29
    v_max_f32 v28, v28, v29
    v_sub_f32 v32, 0xc2c00000, v28
    v_mov_b32 v33, v32
    v_mov_b32 v34, v32
    v_mov_b32 v35, v32
    v_mov_b32 v36, v32
    v_mov_b32 v37, v32
    v_mov_b32 v38, v32
    v_mov_b32 v39, v32
    v_mov_b32 v40, v32
    v_mov_b32 v41, v32
    v_mov_b32 v42, v32
    v_mov_b32 v43, v32
    v_mov_b32 v44, v32
    v_mov_b32 v45, v32
    v_mov_b32 v46, v32
    v_mov_b32 v47, v32
    s_cmp_eq_u32 s51, 0
    s_waitcnt lgkmcnt(1)
    v_mfma_f32_32x32x16_f16 v[48:63], v[8:11], v[4:7], v[32:47]
    ds_read_b128 v[8:11], v21 offset:2064
    ds_read_b128 v[12:15], v22
    v_mov_b32 v72, 0
    v_mov_b32 v73, 0
    v_mov_b32 v74, 0
    v_mov_b32 v75, 0
    v_mov_b32 v76, 0
    v_mov_b32 v77, 0
    v_mov_b32 v78, 0
    v_mov_b32 v79, 0
    v_mov_b32 v92, 0
    v_mov_b32 v93, 0
    v_mov_b32 v94, 0
    v_mov_b32 v95, 0
    s_cbranch_scc0 L_LAG2
    s_nop 0
    s_call_b64 s[58:59], L_BODY
    v_mov_b32 v28, 159952
    s_mov_b32 s39, 2000000
L_LWE:
    ds_read_b32 v29, v28 offset:12
    s_sub_u32 s39, s39, 1
    s_cbranch_scc1 L_LGE
    s_waitcnt lgkmcnt(0)
    v_cmp_gt_u32 vcc, 4, v29
    s_cbranch_vccnz L_LWE
L_LGE:
    s_call_b64 s[58:59], L_BODY
    s_call_b64 s[58:59], L_BODY
    v_mov_b32 v28, 159952
    s_mov_b32 s39, 2000000
L_LWA:
    ds_read_b32 v29, v28 offset:4
    s_sub_u32 s39, s39, 1
    s_cbranch_scc1 L_LGA
    s_waitcnt lgkmcnt(0)
    v_cmp_gt_u32 vcc, 4, v29
    s_cbranch_vccnz L_LWA
L_LGA:
    s_call_b64 s[58:59], L_BODY
    s_add_u32 s48, s42, 0
    buffer_load_dwordx4 v[128:131], v2, s[28:31], s48 offen offset:0 sc1
    buffer_load_dwordx4 v[132:135], v2, s[28:31], s48 offen offset:1024 sc1
    buffer_load_dwordx4 v[136:139], v2, s[28:31], s48 offen offset:2048 sc1
    buffer_load_dwordx4 v[140:143], v2, s[28:31], s48 offen offset:3072 sc1
    s_call_b64 s[58:59], L_BODY
    s_add_u32 s48, s42, 4096
    buffer_load_dwordx4 v[144:147], v2, s[28:31], s48 offen offset:0 sc1
    buffer_load_dwordx4 v[148:151], v2, s[28:31], s48 offen offset:1024 sc1
    buffer_load_dwordx4 v[152:155], v2, s[28:31], s48 offen offset:2048 sc1
    buffer_load_dwordx4 v[156:159], v2, s[28:31], s48 offen offset:3072 sc1
    s_call_b64 s[58:59], L_BODY
    s_add_u32 s48, s42, 8192
    buffer_load_dwordx4 v[160:163], v2, s[28:31], s48 offen offset:0 sc1
    buffer_load_dwordx4 v[164:167], v2, s[28:31], s48 offen offset:1024 sc1
    buffer_load_dwordx4 v[168:171], v2, s[28:31], s48 offen offset:2048 sc1
    buffer_load_dwordx4 v[172:175], v2, s[28:31], s48 offen offset:3072 sc1
    s_call_b64 s[58:59], L_BODY
    s_add_u32 s48, s42, 12288
    buffer_load_dwordx4 v[176:179], v2, s[28:31], s48 offen offset:0 sc1
    buffer_load_dwordx4 v[180:183], v2, s[28:31], s48 offen offset:1024 sc1
    buffer_load_dwordx4 v[184:187], v2, s[28:31], s48 offen offset:2048 sc1
    buffer_load_dwordx4 v[188:191], v2, s[28:31], s48 offen offset:3072 sc1
    s_call_b64 s[58:59], L_BODY
    v_mov_b32 v28, 159952
    s_mov_b32 s39, 2000000
L_LWB:
    ds_read_b32 v29, v28 offset:8
    s_sub_u32 s39, s39, 1
    s_cbranch_scc1 L_LGB
    s_waitcnt lgkmcnt(0)
    v_cmp_gt_u32 vcc, 4, v29
    s_cbranch_vccnz L_LWB
L_LGB:
    s_add_u32 s48, s42, 16384
    buffer_load_dwordx4 v[192:195], v2, s[28:31], s48 offen offset:0 sc1
    buffer_load_dwordx4 v[196:199], v2, s[28:31], s48 offen offset:1024 sc1
    buffer_load_dwordx4 v[200:203], v2, s[28:31], s48 offen offset:2048 sc1
    buffer_load_dwordx4 v[204:207], v2, s[28:31], s48 offen offset:3072 sc1
    s_call_b64 s[58:59], L_BODY
    s_add_u32 s48, s42, 20480
    buffer_load_dwordx4 v[208:211], v2, s[28:31], s48 offen offset:0 sc1
    buffer_load_dwordx4 v[212:215], v2, s[28:31], s48 offen offset:1024 sc1
    buffer_load_dwordx4 v[216:219], v2, s[28:31], s48 offen offset:2048 sc1
    buffer_load_dwordx4 v[220:223], v2, s[28:31], s48 offen offset:3072 sc1
    s_call_b64 s[58:59], L_BODY
    s_add_u32 s48, s42, 24576
    buffer_load_dwordx4 v[224:227], v2, s[28:31], s48 offen offset:0 sc1
    buffer_load_dwordx4 v[228:231], v2, s[28:31], s48 offen offset:1024 sc1
    buffer_load_dwordx4 v[232:235], v2, s[28:31], s48 offen offset:2048 sc1
    buffer_load_dwordx4 v[236:239], v2, s[28:31], s48 offen offset:3072 sc1
    s_call_b64 s[58:59], L_BODY
    s_setprio 0
    s_add_u32 s48, s42, 28672
    buffer_load_dwordx4 v[240:243], v2, s[28:31], s48 offen offset:0 sc1
    buffer_load_dwordx4 v[244:247], v2, s[28:31], s48 offen offset:1024 sc1
    buffer_load_dwordx4 v[248:251], v2, s[28:31], s48 offen offset:2048 sc1
    buffer_load_dwordx4 v[252:255], v2, s[28:31], s48 offen offset:3072 sc1
    s_call_b64 s[58:59], L_BODY
    s_mov_b32 s20, s60
    s_and_b32 s21, s61, 0xffff
    s_mov_b32 s22, 1024
    s_mov_b32 s23, 0x00020000
    s_and_b32 s46, s38, 1
    s_lshl_b32 s46, s46, 9
    s_lshl_b32 s47, s36, 6
    s_add_u32 s46, s46, s47
    s_lshr_b32 s55, s53, 1
    s_lshl_b32 s54, s55, 4
    s_lshl_b32 s55, s55, 14
    s_add_u32 s55, s55, s46
    v_and_b32 v105, 48, v1
    v_and_b32 v104, 15, v1
    v_lshl_add_u32 v104, v104, 10, v105
    buffer_load_dwordx4 v[96:99], v104, s[16:19], s55 offen
    buffer_load_dwordx4 v[100:103], v105, s[20:23], s46 offen
    s_call_b64 s[58:59], L_BODY
    s_call_b64 s[58:59], L_BODY
    s_call_b64 s[58:59], L_BODY
    s_call_b64 s[58:59], L_BODY
L_DONE:
    s_waitcnt lgkmcnt(0)
    v_smfmac_f32_32x32x32_bf16 v[80:95], v[16:19], v[72:79], v20
    s_mov_b32 s44, 0
L_FINISH:
    v_mov_b32 v30, 159952
    ds_read_b32 v31, v30
    s_mov_b32 s39, 2000000
    s_nop 7
    v_mov_b32 v29, v88
    v_add_f32 v28, abs(v80), abs(v81)
    v_add_f32 v28, v28, abs(v82)
    v_permlane32_swap_b32 v88, v29
    v_rcp_f32 v29, v88
    v_add_f32 v28, v28, abs(v83)
    v_add_f32 v28, v28, abs(v84)
    v_add_f32 v28, v28, abs(v85)
    v_add_f32 v28, v28, abs(v86)
    v_add_f32 v28, v28, abs(v87)
    v_cmp_gt_f32 vcc, 0x08800000, v28
    v_fmac_f32 v28, 0x43800000, v88
    s_mov_b64 s[46:47], vcc
    v_pk_mul_f32 v[80:81], v[80:81], v[28:29] op_sel:[0,1] op_sel_hi:[1,1]
    v_pk_mul_f32 v[82:83], v[82:83], v[28:29] op_sel:[0,1] op_sel_hi:[1,1]
    v_pk_mul_f32 v[84:85], v[84:85], v[28:29] op_sel:[0,1] op_sel_hi:[1,1]
    v_pk_mul_f32 v[86:87], v[86:87], v[28:29] op_sel:[0,1] op_sel_hi:[1,1]
    v_cmp_ngt_f32 vcc, 0x7f800000, v28
    s_or_b64 vcc, vcc, s[46:47]
    s_cmp_lg_u32 s44, 0
    s_cbranch_scc1 L_OK
    s_cbranch_vccnz L_RETRY
L_OK:
    v_cvt_pk_bf16_f32 v80, v80, v81
    v_cvt_pk_bf16_f32 v81, v82, v83
    v_cvt_pk_bf16_f32 v82, v84, v85
    v_cvt_pk_bf16_f32 v83, v86, v87
    v_min_u32 v80, -2, v80
    v_min_u32 v81, -2, v81
    v_min_u32 v82, -2, v82
    v_min_u32 v83, -2, v83
L_C2W:
    s_waitcnt lgkmcnt(0)
    v_cmp_eq_u32 vcc, 0, v31
    s_sub_u32 s39, s39, 1
    s_cbranch_scc1 L_C2G
    s_cbranch_vccz L_C2G
    ds_read_b32 v31, v30
    s_branch L_C2W
L_C2G:
    buffer_store_dwordx4 v[80:83], v3, s[28:31], s56 offen sc1
    s_setprio 0
    s_mov_b32 s24, s68
    s_and_b32 s25, s69, 0xffff
    s_mov_b32 s26, 2097152
    s_mov_b32 s27, 0x00020000
    s_lshr_b32 s46, s53, 1
    s_lshl_b32 s46, s46, 14
    s_lshl_b32 s47, s36, 11
    s_add_u32 s46, s46, s47
    s_add_u32 s46, s46, 671744
    v_add_u32 v5, s47, v2
    s_mov_b32 s39, 20000
    s_barrier
    s_waitcnt vmcnt(1)
    v_lshlrev_b32 v16, 16, v96
    v_and_b32 v17, 0xffff0000, v96
    v_lshlrev_b32 v8, 16, v100
    v_and_b32 v9, 0xffff0000, v100
    v_lshlrev_b32 v18, 16, v97
    v_and_b32 v19, 0xffff0000, v97
    v_lshlrev_b32 v10, 16, v101
    v_and_b32 v11, 0xffff0000, v101
    v_lshlrev_b32 v20, 16, v98
    v_and_b32 v21, 0xffff0000, v98
    v_lshlrev_b32 v12, 16, v102
    v_and_b32 v13, 0xffff0000, v102
    v_lshlrev_b32 v22, 16, v99
    v_and_b32 v23, 0xffff0000, v99
    v_lshlrev_b32 v14, 16, v103
    v_and_b32 v15, 0xffff0000, v103
    v_pk_add_f32 v[106:107], v[8:9], v[10:11]
    v_pk_add_f32 v[108:109], v[12:13], v[14:15]
    v_lshlrev_b32 v6, 2, v1
    s_lshl_b32 s47, s36, 8
    s_add_u32 s47, s47, 16384
    v_pk_add_f32 v[106:107], v[106:107], v[108:109]
    v_add_u32 v4, s47, v6
    v_add_u32 v7, 16384, v6
    v_add_f32 v99, v106, v107
    s_lshl_b32 s40, s53, 8
    s_add_u32 s40, s40, 4939776
    s_xor_b32 s41, s40, 256
    v_and_b32 v0, 15, v1
    v_add_u32 v0, s54, v0
    v_sub_u32 v3, 2047, v0
    s_sleep 8
    buffer_load_dwordx4 v[24:27], v2, s[28:31], s46 offen sc1
    buffer_load_dwordx4 v[28:31], v2, s[28:31], s46 offen offset:1024 sc1
L_OP_POLL:
    s_waitcnt vmcnt(0)
    v_max3_u32 v32, v24, v25, v26
    v_max3_u32 v32, v32, v27, v28
    v_max3_u32 v32, v32, v29, v30
    v_max_u32 v32, v32, v31
    v_cmp_eq_u32 vcc, -1, v32
    s_sub_u32 s39, s39, 1
    s_cbranch_scc1 L_OP_OUT
    s_cbranch_vccz L_OP_OUT
    s_sleep 4
    buffer_load_dwordx4 v[24:27], v2, s[28:31], s46 offen sc1
    buffer_load_dwordx4 v[28:31], v2, s[28:31], s46 offen offset:1024 sc1
    s_branch L_OP_POLL
L_OP_OUT:
    ds_write_b128 v5, v[24:27]
    ds_write_b128 v5, v[28:31] offset:1024
    s_waitcnt lgkmcnt(0)
    s_barrier
    ds_read_b128 v[32:35], v2 offset:0
    ds_read_b128 v[36:39], v2 offset:1024
    ds_read_b128 v[40:43], v2 offset:2048
    ds_read_b128 v[44:47], v2 offset:3072
    ds_read_b128 v[48:51], v2 offset:4096
    ds_read_b128 v[52:55], v2 offset:5120
    ds_read_b128 v[56:59], v2 offset:6144
    ds_read_b128 v[60:63], v2 offset:7168
    ds_read_b128 v[64:67], v2 offset:8192
    ds_read_b128 v[68:71], v2 offset:9216
    ds_read_b128 v[72:75], v2 offset:10240
    ds_read_b128 v[76:79], v2 offset:11264
    s_waitcnt lgkmcnt(11)
    v_mfma_f32_16x16x32_bf16 v[16:19], v[128:131], v[32:35], v[16:19]
    ds_read_b128 v[80:83], v2 offset:12288
    v_mfma_f32_16x16x32_bf16 v[20:23], v[132:135], v[32:35], v[20:23]
    s_waitcnt lgkmcnt(11)
    v_mfma_f32_16x16x32_bf16 v[16:19], v[136:139], v[36:39], v[16:19]
    ds_read_b128 v[84:87], v2 offset:13312
    v_mfma_f32_16x16x32_bf16 v[20:23], v[140:143], v[36:39], v[20:23]
    s_waitcnt lgkmcnt(11)
    v_mfma_f32_16x16x32_bf16 v[16:19], v[144:147], v[40:43], v[16:19]
    ds_read_b128 v[88:91], v2 offset:14336
    v_mfma_f32_16x16x32_bf16 v[20:23], v[148:151], v[40:43], v[20:23]
    s_waitcnt lgkmcnt(11)
    v_mfma_f32_16x16x32_bf16 v[16:19], v[152:155], v[44:47], v[16:19]
    ds_read_b128 v[92:95], v2 offset:15360
    v_mfma_f32_16x16x32_bf16 v[20:23], v[156:159], v[44:47], v[20:23]
    s_waitcnt lgkmcnt(11)
    v_mfma_f32_16x16x32_bf16 v[16:19], v[160:163], v[48:51], v[16:19]
    v_mfma_f32_16x16x32_bf16 v[20:23], v[164:167], v[48:51], v[20:23]
    s_waitcnt lgkmcnt(10)
    v_mfma_f32_16x16x32_bf16 v[16:19], v[168:171], v[52:55], v[16:19]
    v_mfma_f32_16x16x32_bf16 v[20:23], v[172:175], v[52:55], v[20:23]
    s_waitcnt lgkmcnt(9)
    v_mfma_f32_16x16x32_bf16 v[16:19], v[176:179], v[56:59], v[16:19]
    v_mfma_f32_16x16x32_bf16 v[20:23], v[180:183], v[56:59], v[20:23]
    s_waitcnt lgkmcnt(8)
    v_mfma_f32_16x16x32_bf16 v[16:19], v[184:187], v[60:63], v[16:19]
    v_mfma_f32_16x16x32_bf16 v[20:23], v[188:191], v[60:63], v[20:23]
    s_waitcnt lgkmcnt(7)
    v_mfma_f32_16x16x32_bf16 v[16:19], v[192:195], v[64:67], v[16:19]
    v_mfma_f32_16x16x32_bf16 v[20:23], v[196:199], v[64:67], v[20:23]
    s_waitcnt lgkmcnt(6)
    v_mfma_f32_16x16x32_bf16 v[16:19], v[200:203], v[68:71], v[16:19]
    v_mfma_f32_16x16x32_bf16 v[20:23], v[204:207], v[68:71], v[20:23]
    s_waitcnt lgkmcnt(5)
    v_mfma_f32_16x16x32_bf16 v[16:19], v[208:211], v[72:75], v[16:19]
    v_mfma_f32_16x16x32_bf16 v[20:23], v[212:215], v[72:75], v[20:23]
    s_waitcnt lgkmcnt(4)
    v_mfma_f32_16x16x32_bf16 v[16:19], v[216:219], v[76:79], v[16:19]
    v_mfma_f32_16x16x32_bf16 v[20:23], v[220:223], v[76:79], v[20:23]
    s_waitcnt lgkmcnt(3)
    v_mfma_f32_16x16x32_bf16 v[16:19], v[224:227], v[80:83], v[16:19]
    v_mfma_f32_16x16x32_bf16 v[20:23], v[228:231], v[80:83], v[20:23]
    s_waitcnt lgkmcnt(2)
    v_mfma_f32_16x16x32_bf16 v[16:19], v[232:235], v[84:87], v[16:19]
    v_mfma_f32_16x16x32_bf16 v[20:23], v[236:239], v[84:87], v[20:23]
    s_waitcnt lgkmcnt(1)
    v_mfma_f32_16x16x32_bf16 v[16:19], v[240:243], v[88:91], v[16:19]
    v_mfma_f32_16x16x32_bf16 v[20:23], v[244:247], v[88:91], v[20:23]
    s_waitcnt lgkmcnt(0)
    v_mfma_f32_16x16x32_bf16 v[16:19], v[248:251], v[92:95], v[16:19]
    v_mfma_f32_16x16x32_bf16 v[20:23], v[252:255], v[92:95], v[20:23]
    s_nop 6
    v_pk_add_f32 v[24:25], v[16:17], v[18:19]
    v_pk_mul_f32 v[26:27], v[16:17], v[16:17]
    v_pk_mul_f32 v[28:29], v[16:17], v[8:9]
    v_pk_fma_f32 v[26:27], v[18:19], v[18:19], v[26:27]
    v_pk_fma_f32 v[28:29], v[18:19], v[10:11], v[28:29]
    v_pk_add_f32 v[24:25], v[24:25], v[20:21]
    v_pk_fma_f32 v[26:27], v[20:21], v[20:21], v[26:27]
    v_pk_fma_f32 v[28:29], v[20:21], v[12:13], v[28:29]
    v_pk_add_f32 v[24:25], v[24:25], v[22:23]
    v_pk_fma_f32 v[26:27], v[22:23], v[22:23], v[26:27]
    v_pk_fma_f32 v[28:29], v[22:23], v[14:15], v[28:29]
    v_add_f32 v96, v24, v25
    v_add_f32 v97, v26, v27
    v_add_f32 v98, v28, v29
    s_nop 0
    v_permlane16_swap_b32 v96, v97
    v_permlane16_swap_b32 v98, v99
    v_add_f32 v96, v96, v97
    v_add_f32 v98, v98, v99
    s_nop 1
    v_permlane32_swap_b32 v96, v98
    v_add_f32 v96, v96, v98
    ds_write_b32 v4, v96
    v_mov_b32 v36, 159936
    v_mov_b32 v37, 0
    ds_write_b32 v36, v37
    s_waitcnt lgkmcnt(0)
    s_barrier
    ds_read2st64_b32 v[24:25], v7 offset0:0 offset1:1
    ds_read2st64_b32 v[26:27], v7 offset0:2 offset1:3
    ds_read2st64_b32 v[28:29], v7 offset0:4 offset1:5
    ds_read2st64_b32 v[30:31], v7 offset0:6 offset1:7
    s_waitcnt lgkmcnt(2)
    v_pk_add_f32 v[24:25], v[24:25], v[26:27]
    s_waitcnt lgkmcnt(0)
    v_pk_add_f32 v[28:29], v[28:29], v[30:31]
    v_pk_add_f32 v[24:25], v[24:25], v[28:29]
    s_cmp_lg_u32 s36, 0
    v_add_f32 v32, v24, v25
    v_min_u32 v32, -2, v32
    s_cbranch_scc1 L_PS_OTH
    buffer_store_dword v32, v6, s[28:31], s40 offen sc1
    s_setprio 3
L_PS_OTH:
    s_sleep 6
L_PS_POLL:
    buffer_load_dword v33, v6, s[28:31], s41 offen sc1
    s_sub_u32 s39, s39, 1
    s_cbranch_scc1 L_PS_OUT
    s_waitcnt vmcnt(0)
    v_cmp_eq_u32 vcc, -1, v33
    s_cbranch_vccz L_PS_OUT
    s_sleep 4
    s_branch L_PS_POLL
L_PS_OUT:
    s_waitcnt vmcnt(0)
    v_add_f32 v32, v32, v33
    v_mov_b32 v34, v32
    s_nop 1
    v_permlane32_swap_b32 v32, v34
    v_mov_b32 v33, v32
    v_mov_b32 v35, v34
    s_nop 0
    v_permlane16_swap_b32 v32, v33
    v_permlane16_swap_b32 v34, v35
    v_mul_f32 v32, 0x3b000000, v32
    v_mul_f32 v33, 0x3b000000, v33
    v_fma_f32 v33, -v32, v32, v33
    v_add_f32 v37, 0x3727c5ac, v33
    v_rsq_f32 v33, v37
    v_fma_f32 v34, -v32, v35, v34
    v_mul_f32 v34, v34, v33
    v_mul_f32 v35, v32, v33
    v_ashrrev_i32 v36, 31, v34
    v_or_b32 v36, 0x80000000, v36
    v_xor_b32 v34, v34, v36
    v_and_b32 v34, 0xfffff800, v34
    v_or_b32 v34, v3, v34
    v_min_u32 v34, -2, v34
    s_nop 1
    v_mov_b32_dpp v26, v34 quad_perm:[1,0,3,2]
    v_max_u32 v24, v34, v26
    v_min_u32 v25, v34, v26
    s_nop 1
    v_mov_b32_dpp v26, v24 quad_perm:[2,3,0,1]
    v_mov_b32_dpp v27, v25 quad_perm:[2,3,0,1]
    v_max_u32 v25, v25, v27
    v_med3_u32 v25, v24, v25, v26
    v_max_u32 v24, v24, v26
    s_nop 1
    v_mov_b32_dpp v26, v24 row_half_mirror
    v_mov_b32_dpp v27, v25 row_half_mirror
    v_max_u32 v25, v25, v27
    v_med3_u32 v25, v24, v25, v26
    v_max_u32 v24, v24, v26
    s_nop 1
    v_mov_b32_dpp v26, v24 row_mirror
    v_mov_b32_dpp v27, v25 row_mirror
    v_max_u32 v25, v25, v27
    v_med3_u32 v25, v24, v25, v26
    v_max_u32 v24, v24, v26
    s_and_b32 s46, s38, 1
    s_or_b32 s46, s46, s36
    v_cmp_ge_u32 s[56:57], v34, v25
    s_cbranch_scc1 L_NOKEY
    s_lshl_b32 s46, s53, 6
    s_add_u32 s46, s46, 4882432
    s_mov_b64 exec, 1
    buffer_store_dwordx2 v[24:25], v2, s[28:31], s46 offen sc1
    s_mov_b64 exec, -1
    v_fma_f32 v39, v37, v33, 1.0
    v_min_u32 v38, -2, v32
    v_min_u32 v39, -2, v39
    v_lshlrev_b32 v36, 3, v0
    s_mov_b32 s46, 4866048
    s_and_b64 exec, s[56:57], 0xffff
    buffer_store_dwordx2 v[38:39], v36, s[28:31], s46 offen sc1
    s_mov_b64 exec, -1
L_NOKEY:
    v_fma_f32 v48, v16, v33, -v35
    v_fma_f32 v49, v17, v33, -v35
    v_fma_f32 v50, v18, v33, -v35
    v_fma_f32 v51, v19, v33, -v35
    v_fma_f32 v52, v20, v33, -v35
    v_fma_f32 v53, v21, v33, -v35
    v_fma_f32 v54, v22, v33, -v35
    v_fma_f32 v55, v23, v33, -v35
    v_pk_add_f32 v[40:41], v[16:17], v[48:49]
    v_pk_add_f32 v[42:43], v[18:19], v[50:51]
    v_pk_add_f32 v[44:45], v[20:21], v[52:53]
    v_pk_add_f32 v[46:47], v[22:23], v[54:55]
    v_cvt_pk_bf16_f32 v48, v48, v49
    v_cvt_pk_bf16_f32 v49, v50, v51
    v_cvt_pk_bf16_f32 v50, v52, v53
    v_cvt_pk_bf16_f32 v51, v54, v55
    v_min_u32 v48, -2, v48
    v_min_u32 v49, -2, v49
    v_min_u32 v50, -2, v50
    v_min_u32 v51, -2, v51
    s_add_u32 s46, s55, 2768896
    v_mov_b32 v61, v104
    s_mov_b64 exec, s[56:57]
    buffer_store_dwordx4 v[48:51], v61, s[28:31], s46 offen sc1
    s_mov_b64 exec, -1
    v_cvt_pk_bf16_f32 v40, v40, v41
    v_cvt_pk_bf16_f32 v41, v42, v43
    v_cvt_pk_bf16_f32 v42, v44, v45
    v_cvt_pk_bf16_f32 v43, v46, v47
    v_add_u32 v60, 1, v34
    s_not_b64 exec, s[56:57]
    buffer_store_dwordx4 v[40:43], v61, s[24:27], s55 offen sc1
    s_mov_b64 exec, -1
    v_lshrrev_b32 v7, 4, v1
    s_lshl_b32 s58, s37, 5
    s_cmp_eq_u32 s36, 0
    s_cbranch_scc1 L_W0
    s_cmp_lt_u32 s2, 224
    s_cbranch_scc1 L_TOPW
    s_branch L_DOWN
L_W0:
    v_bfe_u32 v4, v1, 2, 2
    v_lshl_add_u32 v4, v7, 3, v4
    v_lshlrev_b32 v4, 4, v4
    v_and_b32 v6, 1, v1
    v_lshl_add_u32 v4, v6, 3, v4
    v_bfe_u32 v6, v1, 1, 1
    v_lshl_add_u32 v4, v6, 13, v4
    v_add_u32 v4, 141440, v4
    s_mov_b32 s46, 4882432
    s_mov_b32 s47, 4890624
    s_mov_b32 s39, 20000
    v_lshlrev_b32 v5, 7, v1
    ds_read_b64_tr_b16 v[64:65], v4 offset:0
    ds_read_b64_tr_b16 v[66:67], v4 offset:64
    ds_read_b64_tr_b16 v[68:69], v4 offset:512
    ds_read_b64_tr_b16 v[70:71], v4 offset:576
    ds_read_b64_tr_b16 v[72:73], v4 offset:1024
    ds_read_b64_tr_b16 v[74:75], v4 offset:1088
    ds_read_b64_tr_b16 v[76:77], v4 offset:1536
    ds_read_b64_tr_b16 v[78:79], v4 offset:1600
    s_waitcnt lgkmcnt(4)
    ds_read_b64_tr_b16 v[80:81], v4 offset:2048
    ds_read_b64_tr_b16 v[82:83], v4 offset:2112
    ds_read_b64_tr_b16 v[84:85], v4 offset:2560
    ds_read_b64_tr_b16 v[86:87], v4 offset:2624
    ds_read_b64_tr_b16 v[88:89], v4 offset:3072
    ds_read_b64_tr_b16 v[90:91], v4 offset:3136
    ds_read_b64_tr_b16 v[92:93], v4 offset:3584
    ds_read_b64_tr_b16 v[94:95], v4 offset:3648
    s_waitcnt lgkmcnt(4)
    ds_read_b64_tr_b16 v[96:97], v4 offset:4096
    ds_read_b64_tr_b16 v[98:99], v4 offset:4160
    ds_read_b64_tr_b16 v[100:101], v4 offset:4608
    ds_read_b64_tr_b16 v[102:103], v4 offset:4672
    ds_read_b64_tr_b16 v[104:105], v4 offset:5120
    ds_read_b64_tr_b16 v[106:107], v4 offset:5184
    ds_read_b64_tr_b16 v[108:109], v4 offset:5632
    ds_read_b64_tr_b16 v[110:111], v4 offset:5696
    s_waitcnt lgkmcnt(4)
    ds_read_b64_tr_b16 v[112:113], v4 offset:6144
    ds_read_b64_tr_b16 v[114:115], v4 offset:6208
    ds_read_b64_tr_b16 v[116:117], v4 offset:6656
    ds_read_b64_tr_b16 v[118:119], v4 offset:6720
    ds_read_b64_tr_b16 v[120:121], v4 offset:7168
    ds_read_b64_tr_b16 v[122:123], v4 offset:7232
    ds_read_b64_tr_b16 v[124:125], v4 offset:7680
    ds_read_b64_tr_b16 v[126:127], v4 offset:7744
    buffer_load_dwordx2 v[16:17], v5, s[28:31], s46 offen sc1
    buffer_load_dwordx2 v[18:19], v5, s[28:31], s47 offen sc1
    s_and_b32 s52, s2, 7
    s_mul_i32 s52, s52, 28
    s_lshr_b32 s53, s2, 3
    s_add_u32 s52, s52, s53
    s_lshl_b32 s52, s52, 7
    s_add_u32 s52, s52, 4898816
    v_and_b32 v10, 7, v1
    v_lshlrev_b32 v6, 4, v7
    v_lshl_add_u32 v6, v10, 1, v6
    s_mov_b32 s49, 0
    s_mov_b32 s50, 0
    s_mov_b32 s48, 2768896
    v_mov_b32 v128, 0
    v_mov_b32 v129, 0
    v_mov_b32 v130, 0
    v_mov_b32 v131, 0
    v_mov_b32 v132, 0
    v_mov_b32 v133, 0
    v_mov_b32 v134, 0
    v_mov_b32 v135, 0
    v_mov_b32 v136, 0
    v_mov_b32 v137, 0
    v_mov_b32 v138, 0
    v_mov_b32 v139, 0
    v_mov_b32 v140, 0
    v_mov_b32 v141, 0
    v_mov_b32 v142, 0
    v_mov_b32 v143, 0
    v_mov_b32 v144, 0
    v_mov_b32 v145, 0
    v_mov_b32 v146, 0
    v_mov_b32 v147, 0
    v_mov_b32 v148, 0
    v_mov_b32 v149, 0
    v_mov_b32 v150, 0
    v_mov_b32 v151, 0
    v_mov_b32 v152, 0
    v_mov_b32 v153, 0
    v_mov_b32 v154, 0
    v_mov_b32 v155, 0
    v_mov_b32 v156, 0
    v_mov_b32 v157, 0
    v_mov_b32 v158, 0
    v_mov_b32 v159, 0
    v_mov_b32 v160, 0
    v_mov_b32 v161, 0
    v_mov_b32 v162, 0
    v_mov_b32 v163, 0
    v_mov_b32 v164, 0
    v_mov_b32 v165, 0
    v_mov_b32 v166, 0
    v_mov_b32 v167, 0
    v_mov_b32 v168, 0
    v_mov_b32 v169, 0
    v_mov_b32 v170, 0
    v_mov_b32 v171, 0
    v_mov_b32 v172, 0
    v_mov_b32 v173, 0
    v_mov_b32 v174, 0
    v_mov_b32 v175, 0
    v_mov_b32 v176, 0
    v_mov_b32 v177, 0
    v_mov_b32 v178, 0
    v_mov_b32 v179, 0
    v_mov_b32 v180, 0
    v_mov_b32 v181, 0
    v_mov_b32 v182, 0
    v_mov_b32 v183, 0
    v_mov_b32 v184, 0
    v_mov_b32 v185, 0
    v_mov_b32 v186, 0
    v_mov_b32 v187, 0
    v_mov_b32 v188, 0
    v_mov_b32 v189, 0
    v_mov_b32 v190, 0
    v_mov_b32 v191, 0
L_KEY_POLL:
    s_waitcnt vmcnt(0)
    v_add_u32 v52, 1, v16
    v_add_u32 v53, 1, v17
    v_add_u32 v54, 1, v18
    v_add_u32 v55, 1, v19
    v_min3_u32 v24, v52, v53, v54
    v_min_u32 v24, v24, v55
    v_cmp_eq_u32 vcc, 0, v24
    s_sub_u32 s39, s39, 1
    s_cselect_b32 s51, 0, 1
    s_cbranch_vccnz L_KEY_MISS
    s_mov_b32 s51, 0
    s_branch L_KEY_TOP
L_KEY_MISS:
    s_sleep 4
    buffer_load_dwordx2 v[16:17], v5, s[28:31], s46 offen sc1
    buffer_load_dwordx2 v[18:19], v5, s[28:31], s47 offen sc1
    s_cmp_lg_u32 s51, 0
    s_cbranch_scc1 L_KEY_POLL
L_KEY_TOP:
    v_max_u32 v24, v52, v53
    v_min_u32 v25, v52, v53
    v_med3_u32 v25, v24, v25, v54
    v_max_u32 v24, v24, v54
    v_med3_u32 v25, v24, v25, v55
    v_max_u32 v24, v24, v55
    s_nop 1
    v_mov_b32_dpp v26, v24 quad_perm:[1,0,3,2]
    v_mov_b32_dpp v27, v25 quad_perm:[1,0,3,2]
    v_max_u32 v25, v25, v27
    v_med3_u32 v25, v24, v25, v26
    v_max_u32 v24, v24, v26
    s_nop 1
    v_mov_b32_dpp v26, v24 quad_perm:[2,3,0,1]
    v_mov_b32_dpp v27, v25 quad_perm:[2,3,0,1]
    v_max_u32 v25, v25, v27
    v_med3_u32 v25, v24, v25, v26
    v_max_u32 v24, v24, v26
    s_nop 1
    v_mov_b32_dpp v26, v24 row_half_mirror
    v_mov_b32_dpp v27, v25 row_half_mirror
    v_max_u32 v25, v25, v27
    v_med3_u32 v25, v24, v25, v26
    v_max_u32 v24, v24, v26
    s_nop 1
    v_mov_b32_dpp v26, v24 row_mirror
    v_mov_b32_dpp v27, v25 row_mirror
    v_max_u32 v25, v25, v27
    v_med3_u32 v25, v24, v25, v26
    v_max_u32 v24, v24, v26
    v_mov_b32 v26, v24
    v_mov_b32 v27, v25
    s_nop 1
    v_permlane16_swap_b32 v24, v26
    v_permlane16_swap_b32 v25, v27
    v_max_u32 v25, v25, v27
    v_med3_u32 v25, v24, v25, v26
    v_max_u32 v24, v24, v26
    v_mov_b32 v26, v24
    v_mov_b32 v27, v25
    s_nop 1
    v_permlane32_swap_b32 v24, v26
    v_permlane32_swap_b32 v25, v27
    v_max_u32 v25, v25, v27
    v_med3_u32 v25, v24, v25, v26
    v_max_u32 v24, v24, v26
    s_nop 0
    v_readfirstlane_b32 s44, v24
    v_readfirstlane_b32 s45, v25
    s_cmp_lt_u32 s2, 224
    s_cbranch_scc0 L_KEY_NEXT
    s_cmp_eq_u32 s45, 0
    s_cbranch_scc1 L_KEY_NEXT
    s_cmp_eq_u32 s44, s49
    s_cbranch_scc0 L_UP
    s_cmp_eq_u32 s45, s50
    s_cbranch_scc1 L_KEY_NEXT
L_UP:
    s_mov_b32 s49, s44
    s_mov_b32 s50, s45
    s_sub_u32 s40, s44, 1
    s_sub_u32 s41, s45, 1
    s_andn2_b32 s40, 0x7ff, s40
    s_andn2_b32 s41, 0x7ff, s41
    s_lshl_b32 s40, s40, 10
    s_lshl_b32 s41, s41, 10
    v_and_b32 v4, 1, v1
    v_mov_b32 v3, s40
    v_mov_b32 v12, s41
    v_cmp_eq_u32 vcc, 1, v4
    s_movk_i32 s53, 1000
    s_nop 0
    v_cndmask_b32 v3, v3, v12, vcc
    v_lshl_add_u32 v3, v7, 4, v3
L_HN_POLL:
    s_mov_b32 exec_lo, 0x30003
    s_mov_b32 exec_hi, 0x30003
    buffer_load_dwordx4 v[128:131], v3, s[28:31], s48 offen offset:0 sc1
    buffer_load_dwordx4 v[132:135], v3, s[28:31], s48 offen offset:64 sc1
    buffer_load_dwordx4 v[136:139], v3, s[28:31], s48 offen offset:128 sc1
    buffer_load_dwordx4 v[140:143], v3, s[28:31], s48 offen offset:192 sc1
    buffer_load_dwordx4 v[144:147], v3, s[28:31], s48 offen offset:256 sc1
    buffer_load_dwordx4 v[148:151], v3, s[28:31], s48 offen offset:320 sc1
    buffer_load_dwordx4 v[152:155], v3, s[28:31], s48 offen offset:384 sc1
    buffer_load_dwordx4 v[156:159], v3, s[28:31], s48 offen offset:448 sc1
    buffer_load_dwordx4 v[160:163], v3, s[28:31], s48 offen offset:512 sc1
    buffer_load_dwordx4 v[164:167], v3, s[28:31], s48 offen offset:576 sc1
    buffer_load_dwordx4 v[168:171], v3, s[28:31], s48 offen offset:640 sc1
    buffer_load_dwordx4 v[172:175], v3, s[28:31], s48 offen offset:704 sc1
    buffer_load_dwordx4 v[176:179], v3, s[28:31], s48 offen offset:768 sc1
    buffer_load_dwordx4 v[180:183], v3, s[28:31], s48 offen offset:832 sc1
    buffer_load_dwordx4 v[184:187], v3, s[28:31], s48 offen offset:896 sc1
    buffer_load_dwordx4 v[188:191], v3, s[28:31], s48 offen offset:960 sc1
    s_mov_b64 exec, -1
    v_mov_b32 v8, 0
    v_mov_b32 v9, 0
    v_mov_b32 v10, 0
    v_mov_b32 v11, 0
    v_mov_b32 v12, 0
    s_waitcnt lgkmcnt(0)
    s_waitcnt vmcnt(15)
    v_mfma_f32_16x16x32_bf16 v[8:11], v[128:131], v[64:67], v[8:11]
    v_max3_u32 v12, v12, v128, v129
    v_max3_u32 v12, v12, v130, v131
    s_waitcnt vmcnt(14)
    v_mfma_f32_16x16x32_bf16 v[8:11], v[132:135], v[68:71], v[8:11]
    v_max3_u32 v12, v12, v132, v133
    v_max3_u32 v12, v12, v134, v135
    s_waitcnt vmcnt(13)
    v_mfma_f32_16x16x32_bf16 v[8:11], v[136:139], v[72:75], v[8:11]
    v_max3_u32 v12, v12, v136, v137
    v_max3_u32 v12, v12, v138, v139
    s_waitcnt vmcnt(12)
    v_mfma_f32_16x16x32_bf16 v[8:11], v[140:143], v[76:79], v[8:11]
    v_max3_u32 v12, v12, v140, v141
    v_max3_u32 v12, v12, v142, v143
    s_waitcnt vmcnt(11)
    v_mfma_f32_16x16x32_bf16 v[8:11], v[144:147], v[80:83], v[8:11]
    v_max3_u32 v12, v12, v144, v145
    v_max3_u32 v12, v12, v146, v147
    s_waitcnt vmcnt(10)
    v_mfma_f32_16x16x32_bf16 v[8:11], v[148:151], v[84:87], v[8:11]
    v_max3_u32 v12, v12, v148, v149
    v_max3_u32 v12, v12, v150, v151
    s_waitcnt vmcnt(9)
    v_mfma_f32_16x16x32_bf16 v[8:11], v[152:155], v[88:91], v[8:11]
    v_max3_u32 v12, v12, v152, v153
    v_max3_u32 v12, v12, v154, v155
    s_waitcnt vmcnt(8)
    v_mfma_f32_16x16x32_bf16 v[8:11], v[156:159], v[92:95], v[8:11]
    v_max3_u32 v12, v12, v156, v157
    v_max3_u32 v12, v12, v158, v159
    s_waitcnt vmcnt(7)
    v_mfma_f32_16x16x32_bf16 v[8:11], v[160:163], v[96:99], v[8:11]
    v_max3_u32 v12, v12, v160, v161
    v_max3_u32 v12, v12, v162, v163
    s_waitcnt vmcnt(6)
    v_mfma_f32_16x16x32_bf16 v[8:11], v[164:167], v[100:103], v[8:11]
    v_max3_u32 v12, v12, v164, v165
    v_max3_u32 v12, v12, v166, v167
    s_waitcnt vmcnt(5)
    v_mfma_f32_16x16x32_bf16 v[8:11], v[168:171], v[104:107], v[8:11]
    v_max3_u32 v12, v12, v168, v169
    v_max3_u32 v12, v12, v170, v171
    s_waitcnt vmcnt(4)
    v_mfma_f32_16x16x32_bf16 v[8:11], v[172:175], v[108:111], v[8:11]
    v_max3_u32 v12, v12, v172, v173
    v_max3_u32 v12, v12, v174, v175
    s_waitcnt vmcnt(3)
    v_mfma_f32_16x16x32_bf16 v[8:11], v[176:179], v[112:115], v[8:11]
    v_max3_u32 v12, v12, v176, v177
    v_max3_u32 v12, v12, v178, v179
    s_waitcnt vmcnt(2)
    v_mfma_f32_16x16x32_bf16 v[8:11], v[180:183], v[116:119], v[8:11]
    v_max3_u32 v12, v12, v180, v181
    v_max3_u32 v12, v12, v182, v183
    s_waitcnt vmcnt(1)
    v_mfma_f32_16x16x32_bf16 v[8:11], v[184:187], v[120:123], v[8:11]
    v_max3_u32 v12, v12, v184, v185
    v_max3_u32 v12, v12, v186, v187
    s_waitcnt vmcnt(0)
    v_mfma_f32_16x16x32_bf16 v[8:11], v[188:191], v[124:127], v[8:11]
    v_max3_u32 v12, v12, v188, v189
    v_max3_u32 v12, v12, v190, v191
    v_cmp_eq_u32 vcc, -1, v12
    s_sub_u32 s53, s53, 1
    s_cbranch_scc1 L_HN_OUT
    s_cbranch_vccz L_HN_OUT
    s_sleep 2
    s_branch L_HN_POLL
L_HN_OUT:
    s_nop 2
    v_permlane16_swap_b32 v8, v9
    v_mul_f32 v12, 0xbfb8aa3b, v8
    v_exp_f32 v12, v12
    v_mov_b32_dpp v14, v8 row_ror:8
    v_add_f32 v12, 1.0, v12
    v_rcp_f32 v12, v12
    v_mul_f32 v8, v8, v14
    v_mul_f32 v8, v8, v12
    s_nop 1
    v_mov_b32_dpp v9, v8 quad_perm:[1,0,3,2]
    v_cvt_pk_bf16_f32 v8, v8, v9
    v_min_u32 v8, -2, v8
L_KEY_NEXT:
    s_cmp_lg_u32 s51, 0
    s_cbranch_scc1 L_KEY_POLL
    s_cmp_lt_u32 s2, 224
    s_cbranch_scc0 L_DN0
    s_mov_b64 exec, 0x550055
    buffer_store_dword v8, v6, s[28:31], s52 offen sc1
    s_mov_b64 exec, -1
L_NOACT:
    v_mov_b32 v36, 159936
    ds_write_b64 v36, v[24:25]
    s_waitcnt lgkmcnt(0)
L_TOPW:
    s_barrier
    s_cmp_eq_u32 s36, 0
    s_cbranch_scc1 L_W0B
    v_mov_b32 v36, 159936
    ds_read_b64 v[24:25], v36
    s_waitcnt lgkmcnt(0)
    v_readfirstlane_b32 s44, v24
    v_readfirstlane_b32 s45, v25
    s_nop 1
L_HAVETOP:
    v_cmp_gt_u32 vcc, s45, v60
    s_and_b64 exec, vcc, s[56:57]
    s_cbranch_execz L_CSA
    buffer_store_dwordx4 v[40:43], v61, s[24:27], s55 offen sc1
L_CSA:
    s_mov_b64 exec, -1
L_END:
    s_endpgm
L_W0B:
    s_cmp_lt_u32 s2, 224
    s_cbranch_scc1 L_HAVETOP
    ds_read2_b32 v[26:27], v6 offset0:0 offset1:32
    ds_read2_b32 v[28:29], v6 offset0:64 offset1:96
    ds_read2_b32 v[30:31], v6 offset0:128 offset1:160
    ds_read_b32 v32, v6 offset:768
    s_waitcnt lgkmcnt(1)
    v_pk_add_f32 v[26:27], v[26:27], v[28:29]
    v_pk_add_f32 v[26:27], v[26:27], v[30:31]
    v_add_f32 v26, v26, v27
    s_waitcnt lgkmcnt(0)
    v_add_f32 v26, v26, v32
    v_fmac_f32 v14, v26, v16
    v_cvt_pk_bf16_f32 v14, v14, v14
    buffer_store_short v14, v13, s[24:27], s58 offen
    s_endpgm
L_DN0:
    v_mov_b32 v36, 159936
    ds_write_b64 v36, v[24:25]
    v_and_b32 v6, 1, v7
    v_cmp_eq_u32 vcc, 1, v6
    s_add_u32 s41, s58, 2768896
    s_mov_b32 s43, 4866048
    v_cndmask_b32 v12, v24, v25, vcc
    v_add_u32 v12, -1, v12
    v_not_b32 v13, v12
    v_and_b32 v13, 0x7ff, v13
    v_and_b32 v14, 14, v1
    v_lshlrev_b32 v14, 1, v14
    v_lshl_add_u32 v15, v13, 10, v14
    v_lshlrev_b32 v20, 3, v13
    s_movk_i32 s53, 1000
L_BS_POLL:
    buffer_load_dword v14, v15, s[28:31], s41 offen sc1
    buffer_load_dwordx2 v[18:19], v20, s[28:31], s43 offen sc1
    s_sub_u32 s53, s53, 1
    s_cbranch_scc1 L_BS_OUT
    s_waitcnt vmcnt(0)
    v_max3_u32 v17, v14, v18, v19
    v_cmp_eq_u32 vcc, -1, v17
    s_cbranch_vccnz L_BS_POLL
L_BS_OUT:
    v_and_b32 v21, 15, v1
    v_lshlrev_b32 v21, 1, v21
    v_lshl_add_u32 v13, v13, 10, v21
    v_not_b32 v16, v12
    v_ashrrev_i32 v16, 31, v16
    v_or_b32 v16, 0x80000000, v16
    v_xor_b32 v16, v16, v12
    v_mul_f32 v16, 0xbfb8aa3b, v16
    v_exp_f32 v16, v16
    v_and_b32 v6, 1, v1
    v_add_f32 v16, 1.0, v16
    v_rcp_f32 v16, v16
    v_cmp_eq_u32 vcc, 1, v6
    s_waitcnt vmcnt(0)
    v_lshlrev_b32 v17, 16, v14
    v_and_b32 v14, 0xffff0000, v14
    v_cndmask_b32 v14, v17, v14, vcc
    v_and_b32 v6, 31, v1
    v_lshlrev_b32 v6, 2, v6
    v_add_u32 v6, 160000, v6
    v_fma_f32 v14, v14, v19, v18
    v_cmp_gt_u32 vcc, s45, v60
    s_and_b64 exec, vcc, s[56:57]
    s_cbranch_execz L_CSB
    buffer_store_dwordx4 v[40:43], v61, s[24:27], s55 offen sc1
L_CSB:
    s_mov_b64 exec, -1
    s_branch L_TOPW
L_DOWN:
    s_mov_b32 s32, s66
    s_and_b32 s33, s67, 0xffff
    s_mov_b32 s34, 1835008
    s_mov_b32 s35, 0x00020000
    v_lshrrev_b32 v5, 1, v1
    v_lshlrev_b32 v5, 10, v5
    v_and_b32 v6, 1, v1
    v_lshl_add_u32 v5, v6, 4, v5
    s_sub_u32 s42, s36, 1
    s_lshl_b32 s46, s42, 18
    s_add_u32 s46, s46, s58
    s_mul_i32 s59, s42, 6144
    s_add_u32 s59, s59, 65536
    s_add_u32 m0, s59, 0
    s_add_u32 s47, s46, 65536
    buffer_load_dwordx4 v5, s[32:35], s47 offen lds
    s_add_u32 m0, s59, 1024
    s_add_u32 s47, s46, 98304
    buffer_load_dwordx4 v5, s[32:35], s47 offen lds
    s_add_u32 m0, s59, 2048
    s_add_u32 s47, s46, 131072
    buffer_load_dwordx4 v5, s[32:35], s47 offen lds
    s_add_u32 m0, s59, 3072
    s_add_u32 s47, s46, 163840
    buffer_load_dwordx4 v5, s[32:35], s47 offen lds
    s_add_u32 m0, s59, 4096
    s_add_u32 s47, s46, 196608
    buffer_load_dwordx4 v5, s[32:35], s47 offen lds
    s_add_u32 m0, s59, 5120
    s_add_u32 s47, s46, 229376
    buffer_load_dwordx4 v5, s[32:35], s47 offen lds
    v_bfe_u32 v4, v1, 2, 2
    v_lshl_add_u32 v4, v7, 3, v4
    v_lshlrev_b32 v4, 5, v4
    v_and_b32 v3, 3, v1
    v_lshl_add_u32 v4, v3, 3, v4
    s_lshl_b32 s47, s42, 11
    s_add_u32 s47, s47, 141440
    v_add_u32 v3, s47, v4
    v_add_u32 v4, s59, v4
    v_lshrrev_b32 v5, 1, v1
    v_lshlrev_b32 v5, 7, v5
    v_lshl_add_u32 v5, v6, 4, v5
    s_lshl_b32 s48, s36, 10
    v_add_u32 v12, s48, v2
    v_lshl_add_u32 v13, v7, 1, v6
    v_lshl_add_u32 v13, v13, 4, s48
    s_lshl_b32 s48, s42, 12
    s_add_u32 s48, s48, 4898816
    s_mov_b32 s39, 20000
    ds_read_b64_tr_b16 v[64:65], v3 offset:0
    ds_read_b64_tr_b16 v[66:67], v3 offset:128
    ds_read_b64_tr_b16 v[68:69], v3 offset:1024
    ds_read_b64_tr_b16 v[70:71], v3 offset:1152
    s_lshl_b32 s42, s42, 7
    s_add_u32 s42, s42, 160000
    v_and_b32 v3, 15, v1
    v_lshl_add_u32 v3, v3, 2, s42
    v_mov_b32 v8, 0
    v_mov_b32 v9, 0
    v_mov_b32 v10, 0
    v_mov_b32 v11, 0
    s_waitcnt vmcnt(0) lgkmcnt(0)
    ds_read_b64_tr_b16 v[72:73], v4 offset:0
    ds_read_b64_tr_b16 v[74:75], v4 offset:128
    ds_read_b64_tr_b16 v[76:77], v4 offset:1024
    ds_read_b64_tr_b16 v[78:79], v4 offset:1152
    ds_read_b64_tr_b16 v[80:81], v4 offset:2048
    ds_read_b64_tr_b16 v[82:83], v4 offset:2176
    ds_read_b64_tr_b16 v[84:85], v4 offset:3072
    ds_read_b64_tr_b16 v[86:87], v4 offset:3200
    ds_read_b64_tr_b16 v[88:89], v4 offset:4096
    ds_read_b64_tr_b16 v[90:91], v4 offset:4224
    ds_read_b64_tr_b16 v[92:93], v4 offset:5120
    ds_read_b64_tr_b16 v[94:95], v4 offset:5248
    v_mov_b32 v36, 159936
    s_mov_b32 s53, 2000000
L_DW:
    ds_read_b64 v[24:25], v36
    s_sub_u32 s53, s53, 1
    s_cbranch_scc1 L_DG
    s_waitcnt lgkmcnt(0)
    v_cmp_eq_u32 vcc, 0, v24
    s_cbranch_vccnz L_DW
L_DG:
    v_readfirstlane_b32 s45, v25
    s_nop 1
    v_cmp_gt_u32 vcc, s45, v60
    s_and_b64 exec, vcc, s[56:57]
    s_cbranch_execz L_CSC
    buffer_store_dwordx4 v[40:43], v61, s[24:27], s55 offen sc1
L_CSC:
    s_mov_b64 exec, -1
    s_sleep 20
    buffer_load_dwordx4 v[16:19], v5, s[28:31], s48 offen sc1
    s_sleep 8
L_ACT_POLL:
    buffer_load_dwordx4 v[20:23], v5, s[28:31], s48 offen sc1
    s_waitcnt vmcnt(1)
    v_max3_u32 v14, v16, v17, v18
    v_max_u32 v14, v14, v19
    v_cmp_eq_u32 vcc, -1, v14
    s_cbranch_vccz L_ACT0
    buffer_load_dwordx4 v[16:19], v5, s[28:31], s48 offen sc1
    s_waitcnt vmcnt(1)
    v_max3_u32 v14, v20, v21, v22
    v_max_u32 v14, v14, v23
    v_cmp_eq_u32 vcc, -1, v14
    s_sub_u32 s39, s39, 1
    s_cbranch_scc1 L_ACT1
    s_cbranch_vccnz L_ACT_POLL
L_ACT1:
    ds_write_b128 v12, v[20:23]
    s_branch L_ACT2
L_ACT0:
    ds_write_b128 v12, v[16:19]
L_ACT2:
    ds_read_b128 v[128:131], v13 offset:0
    ds_read_b128 v[132:135], v13 offset:128
    ds_read_b128 v[136:139], v13 offset:256
    ds_read_b128 v[140:143], v13 offset:384
    ds_read_b128 v[144:147], v13 offset:512
    ds_read_b128 v[148:151], v13 offset:640
    ds_read_b128 v[152:155], v13 offset:768
    ds_read_b128 v[156:159], v13 offset:896
    s_waitcnt lgkmcnt(7)
    v_mfma_f32_16x16x32_bf16 v[8:11], v[128:131], v[64:67], v[8:11]
    s_waitcnt lgkmcnt(6)
    v_mfma_f32_16x16x32_bf16 v[8:11], v[132:135], v[68:71], v[8:11]
    s_waitcnt lgkmcnt(5)
    v_mfma_f32_16x16x32_bf16 v[8:11], v[136:139], v[72:75], v[8:11]
    s_waitcnt lgkmcnt(4)
    v_mfma_f32_16x16x32_bf16 v[8:11], v[140:143], v[76:79], v[8:11]
    s_waitcnt lgkmcnt(3)
    v_mfma_f32_16x16x32_bf16 v[8:11], v[144:147], v[80:83], v[8:11]
    s_waitcnt lgkmcnt(2)
    v_mfma_f32_16x16x32_bf16 v[8:11], v[148:151], v[84:87], v[8:11]
    s_waitcnt lgkmcnt(1)
    v_mfma_f32_16x16x32_bf16 v[8:11], v[152:155], v[88:91], v[8:11]
    s_waitcnt lgkmcnt(0)
    v_mfma_f32_16x16x32_bf16 v[8:11], v[156:159], v[92:95], v[8:11]
    s_nop 7
    ds_write2_b32 v3, v8, v9 offset1:16
    s_waitcnt lgkmcnt(0)
    s_barrier
    s_endpgm
    .p2align 6
L_BODY:
    v_exp_f32 v48, v48
    v_exp_f32 v49, v49
    s_waitcnt lgkmcnt(0)
    v_smfmac_f32_32x32x32_bf16 v[80:95], v[16:19], v[72:79], v20
    ds_read_b128 v[16:19], v23 offset:0
    v_exp_f32 v50, v50
    v_exp_f32 v51, v51
    v_exp_f32 v52, v52
    v_exp_f32 v53, v53
    v_mfma_f32_32x32x16_f16 v[64:79], v[8:11], v[4:7], v[32:47]
    ds_read_b128 v[8:11], v21 offset:4128
    v_exp_f32 v54, v54
    v_exp_f32 v55, v55
    v_exp_f32 v56, v56
    v_exp_f32 v57, v57
    v_exp_f32 v58, v58
    v_smfmac_f32_32x32x32_bf16 v[80:95], v[12:15], v[48:55], v20
    ds_read_b128 v[12:15], v22 offset:2064
    v_exp_f32 v59, v59
    v_exp_f32 v60, v60
    v_exp_f32 v61, v61
    v_exp_f32 v62, v62
    v_exp_f32 v63, v63
    v_exp_f32 v64, v64
    v_exp_f32 v65, v65
    s_waitcnt lgkmcnt(0)
    v_smfmac_f32_32x32x32_bf16 v[80:95], v[16:19], v[56:63], v20
    ds_read_b128 v[16:19], v23 offset:2064
    v_exp_f32 v66, v66
    v_exp_f32 v67, v67
    v_exp_f32 v68, v68
    v_exp_f32 v69, v69
    v_mfma_f32_32x32x16_f16 v[48:63], v[8:11], v[4:7], v[32:47]
    ds_read_b128 v[8:11], v21 offset:6192
    v_exp_f32 v70, v70
    v_exp_f32 v71, v71
    v_exp_f32 v72, v72
    v_exp_f32 v73, v73
    v_exp_f32 v74, v74
    v_smfmac_f32_32x32x32_bf16 v[80:95], v[12:15], v[64:71], v20
    ds_read_b128 v[12:15], v22 offset:4128
    v_exp_f32 v75, v75
    v_exp_f32 v76, v76
    v_exp_f32 v77, v77
    v_exp_f32 v78, v78
    v_exp_f32 v79, v79
    v_exp_f32 v48, v48
    v_exp_f32 v49, v49
    s_waitcnt lgkmcnt(0)
    v_smfmac_f32_32x32x32_bf16 v[80:95], v[16:19], v[72:79], v20
    ds_read_b128 v[16:19], v23 offset:4128
    v_exp_f32 v50, v50
    v_exp_f32 v51, v51
    v_exp_f32 v52, v52
    v_exp_f32 v53, v53
    v_mfma_f32_32x32x16_f16 v[64:79], v[8:11], v[4:7], v[32:47]
    ds_read_b128 v[8:11], v21 offset:8256
    v_exp_f32 v54, v54
    v_exp_f32 v55, v55
    v_exp_f32 v56, v56
    v_exp_f32 v57, v57
    v_exp_f32 v58, v58
    v_smfmac_f32_32x32x32_bf16 v[80:95], v[12:15], v[48:55], v20
    ds_read_b128 v[12:15], v22 offset:6192
    v_exp_f32 v59, v59
    v_exp_f32 v60, v60
    v_exp_f32 v61, v61
    v_exp_f32 v62, v62
    v_exp_f32 v63, v63
    v_exp_f32 v64, v64
    v_exp_f32 v65, v65
    s_waitcnt lgkmcnt(0)
    v_smfmac_f32_32x32x32_bf16 v[80:95], v[16:19], v[56:63], v20
    ds_read_b128 v[16:19], v23 offset:6192
    v_exp_f32 v66, v66
    v_exp_f32 v67, v67
    v_exp_f32 v68, v68
    v_exp_f32 v69, v69
    v_mfma_f32_32x32x16_f16 v[48:63], v[8:11], v[4:7], v[32:47]
    ds_read_b128 v[8:11], v21 offset:10320
    v_exp_f32 v70, v70
    v_exp_f32 v71, v71
    v_exp_f32 v72, v72
    v_exp_f32 v73, v73
    v_exp_f32 v74, v74
    v_smfmac_f32_32x32x32_bf16 v[80:95], v[12:15], v[64:71], v20
    ds_read_b128 v[12:15], v22 offset:8256
    v_exp_f32 v75, v75
    v_exp_f32 v76, v76
    v_exp_f32 v77, v77
    v_exp_f32 v78, v78
    v_exp_f32 v79, v79
    v_add_u32 v21, 8256, v21
    v_add_u32 v22, 8256, v22
    v_add_u32 v23, 8256, v23
    s_setpc_b64 s[58:59]
L_LAG:
    s_mov_b32 s39, 20000
L_CK_POLL:
    s_waitcnt vmcnt(0)
    v_cmp_gt_u32 vcc, 8, v31
    s_sub_u32 s39, s39, 1
    s_cbranch_scc1 L_CK_OUT
    s_cbranch_vccz L_CK_OUT
    s_sleep 2
    global_load_dword v31, v30, s[72:73] sc1
    s_branch L_CK_POLL
L_CK_OUT:
    s_add_u32 s46, s36, 12
    s_mul_i32 s47, s46, 2064
    s_lshl_b32 s46, s46, 11
    s_mov_b32 s48, 12
L_B2:
    s_mov_b32 m0, s47
    s_addk_i32 s47, 8256
    buffer_load_dwordx4 v2, s[28:31], s46 offen sc1 lds
    buffer_load_dwordx4 v2, s[28:31], s46 offen offset:1024 sc1 lds
    s_addk_i32 s46, 8192
    s_sub_u32 s48, s48, 1
    s_cmp_lg_u32 s48, 0
    s_cbranch_scc1 L_B2
    s_mov_b32 s24, s46
    s_mov_b32 s25, s47
    s_branch L_QFIN
L_LAG2:
    s_waitcnt vmcnt(14)
    v_mov_b32 v28, 159952
    v_mov_b32 v29, 1
    s_mov_b64 exec, 1
    ds_add_u32 v28, v29 offset:4
    s_mov_b64 exec, -1
    s_setprio 1
    v_mov_b32 v28, -1
    v_mov_b32 v29, -1
    v_mov_b32 v30, -1
    v_mov_b32 v31, -1
    s_sub_u32 s47, s56, 512
    buffer_store_dwordx4 v[28:31], v3, s[28:31], s56 offen sc1
    buffer_store_dwordx4 v[28:31], v3, s[28:31], s47 offen sc1
    s_add_u32 s46, s55, 2768896
    s_sub_u32 s47, s46, 4096
    buffer_store_dwordx4 v[28:31], v2, s[28:31], s46 offen sc1
    buffer_store_dwordx4 v[28:31], v2, s[28:31], s47 offen sc1
    s_and_b32 s45, s2, 7
    s_mul_i32 s45, s45, 28
    s_lshr_b32 s48, s2, 3
    s_add_u32 s45, s45, s48
    s_cmp_eq_u32 s36, 4
    s_cbranch_scc0 L_NOS4
    s_lshl_b32 s47, s53, 8
    s_add_u32 s47, s47, 4939776
    s_mov_b64 exec, 0xffff
    buffer_store_dwordx4 v[28:31], v2, s[28:31], s47 offen sc1
    s_lshl_b32 s47, s2, 6
    s_add_u32 s47, s47, 4882432
    s_lshl_b32 s46, s45, 7
    s_add_u32 s46, s46, 4898816
    s_lshl_b32 s39, s53, 6
    s_add_u32 s39, s39, 4866048
    s_mov_b64 exec, 15
    buffer_store_dwordx4 v[28:31], v2, s[28:31], s39 offen sc1
    s_mov_b64 exec, 1
    buffer_store_dwordx2 v[28:29], v2, s[28:31], s47 offen sc1
    s_cmp_ge_u32 s48, 28
    s_cbranch_scc1 L_NOS4B
    s_mov_b64 exec, 3
    buffer_store_dwordx4 v[28:31], v2, s[28:31], s46 offen sc1
L_NOS4B:
    s_mov_b64 exec, -1
L_NOS4:
    s_lshl_b32 s45, s45, 4
    s_and_b32 s47, s36, 3
    s_lshl_b32 s43, s47, 11
    s_mul_i32 s47, s47, 458752
    s_add_u32 s45, s45, s47
    v_mul_u32_u24 v24, 3584, v1
    s_mov_b32 s34, 1835008
    s_mov_b32 s35, 0x00020000
    s_mov_b32 s40, 229376
    s_mov_b32 s41, 0
    s_mov_b64 s[14:15], s[62:63]
    s_mov_b64 s[12:13], s[64:65]
    s_cmp_lt_u32 s2, 224
    s_cbranch_scc1 L_UPWG
    s_mov_b64 s[14:15], s[66:67]
    s_mov_b64 s[12:13], s[66:67]
    s_mov_b32 s40, 32768
    s_mov_b32 s41, 0x100000
    s_lshl_b32 s45, s43, 7
    s_lshl_b32 s47, s37, 5
    s_add_u32 s45, s45, s47
    v_lshrrev_b32 v24, 1, v1
    v_lshlrev_b32 v24, 10, v24
    v_and_b32 v25, 1, v1
    v_lshl_add_u32 v24, v25, 4, v24
L_UPWG:
    s_call_b64 s[58:59], L_BODY
    s_waitcnt vmcnt(0)
    v_mov_b32 v28, 159952
    s_mov_b32 s39, 2000000
L_LWF:
    ds_read_b32 v29, v28 offset:12
    s_sub_u32 s39, s39, 1
    s_cbranch_scc1 L_LGF
    s_waitcnt lgkmcnt(0)
    v_cmp_gt_u32 vcc, 4, v29
    s_cbranch_vccnz L_LWF
L_LGF:
    v_mov_b32 v28, 159952
    v_mov_b32 v29, 1
    s_mov_b64 exec, 1
    ds_add_u32 v28, v29 offset:8
    s_mov_b64 exec, -1
    s_lshr_b32 s46, s2, 2
    s_lshl_b32 s46, s46, 7
    s_add_u32 s46, s46, 4931588
    v_mov_b32 v28, s46
    v_mov_b32 v29, 1
    s_mov_b64 exec, 1
    global_atomic_add v28, v29, s[72:73] sc1
    s_mov_b64 exec, -1
    s_add_u32 s48, s42, 0
    buffer_load_dwordx4 v[128:131], v2, s[28:31], s48 offen offset:0 sc1
    buffer_load_dwordx4 v[132:135], v2, s[28:31], s48 offen offset:1024 sc1
    buffer_load_dwordx4 v[136:139], v2, s[28:31], s48 offen offset:2048 sc1
    buffer_load_dwordx4 v[140:143], v2, s[28:31], s48 offen offset:3072 sc1
    s_call_b64 s[58:59], L_BODY
    s_add_u32 s48, s42, 4096
    buffer_load_dwordx4 v[144:147], v2, s[28:31], s48 offen offset:0 sc1
    buffer_load_dwordx4 v[148:151], v2, s[28:31], s48 offen offset:1024 sc1
    buffer_load_dwordx4 v[152:155], v2, s[28:31], s48 offen offset:2048 sc1
    buffer_load_dwordx4 v[156:159], v2, s[28:31], s48 offen offset:3072 sc1
    s_call_b64 s[58:59], L_BODY
    v_mov_b32 v28, 159952
    s_mov_b32 s39, 2000000
L_LWC:
    ds_read_b32 v29, v28 offset:8
    s_sub_u32 s39, s39, 1
    s_cbranch_scc1 L_LGC
    s_waitcnt lgkmcnt(0)
    v_cmp_gt_u32 vcc, 4, v29
    s_cbranch_vccnz L_LWC
L_LGC:
    s_add_u32 s48, s42, 8192
    buffer_load_dwordx4 v[160:163], v2, s[28:31], s48 offen offset:0 sc1
    buffer_load_dwordx4 v[164:167], v2, s[28:31], s48 offen offset:1024 sc1
    buffer_load_dwordx4 v[168:171], v2, s[28:31], s48 offen offset:2048 sc1
    buffer_load_dwordx4 v[172:175], v2, s[28:31], s48 offen offset:3072 sc1
    s_call_b64 s[58:59], L_BODY
    s_add_u32 s48, s42, 12288
    buffer_load_dwordx4 v[176:179], v2, s[28:31], s48 offen offset:0 sc1
    buffer_load_dwordx4 v[180:183], v2, s[28:31], s48 offen offset:1024 sc1
    buffer_load_dwordx4 v[184:187], v2, s[28:31], s48 offen offset:2048 sc1
    buffer_load_dwordx4 v[188:191], v2, s[28:31], s48 offen offset:3072 sc1
    s_call_b64 s[58:59], L_BODY
    s_add_u32 s48, s42, 16384
    buffer_load_dwordx4 v[192:195], v2, s[28:31], s48 offen offset:0 sc1
    buffer_load_dwordx4 v[196:199], v2, s[28:31], s48 offen offset:1024 sc1
    buffer_load_dwordx4 v[200:203], v2, s[28:31], s48 offen offset:2048 sc1
    buffer_load_dwordx4 v[204:207], v2, s[28:31], s48 offen offset:3072 sc1
    s_call_b64 s[58:59], L_BODY
    s_add_u32 s48, s42, 20480
    buffer_load_dwordx4 v[208:211], v2, s[28:31], s48 offen offset:0 sc1
    buffer_load_dwordx4 v[212:215], v2, s[28:31], s48 offen offset:1024 sc1
    buffer_load_dwordx4 v[216:219], v2, s[28:31], s48 offen offset:2048 sc1
    buffer_load_dwordx4 v[220:223], v2, s[28:31], s48 offen offset:3072 sc1
    s_call_b64 s[58:59], L_BODY
    s_add_u32 s48, s42, 24576
    buffer_load_dwordx4 v[224:227], v2, s[28:31], s48 offen offset:0 sc1
    buffer_load_dwordx4 v[228:231], v2, s[28:31], s48 offen offset:1024 sc1
    buffer_load_dwordx4 v[232:235], v2, s[28:31], s48 offen offset:2048 sc1
    buffer_load_dwordx4 v[236:239], v2, s[28:31], s48 offen offset:3072 sc1
    s_call_b64 s[58:59], L_BODY
    s_add_u32 s48, s42, 28672
    buffer_load_dwordx4 v[240:243], v2, s[28:31], s48 offen offset:0 sc1
    buffer_load_dwordx4 v[244:247], v2, s[28:31], s48 offen offset:1024 sc1
    buffer_load_dwordx4 v[248:251], v2, s[28:31], s48 offen offset:2048 sc1
    buffer_load_dwordx4 v[252:255], v2, s[28:31], s48 offen offset:3072 sc1
    s_lshr_b32 s46, s2, 3
    s_and_b32 s47, s2, 7
    s_cmp_eq_u32 s36, 7
    s_cbranch_scc0 L_WU1
    s_mov_b32 s20, s66
    s_mov_b32 s21, s67
    s_mov_b32 s22, 1835008
    v_lshlrev_b32 v28, 10, v1
    s_mul_i32 s46, s46, 57344
    s_lshl_b32 s47, s47, 7
    s_branch L_WU2
L_WU1:
    s_cmp_eq_u32 s36, 6
    s_cbranch_scc1 L_WU4
    s_cmp_eq_u32 s36, 4
    s_cselect_b32 s20, s62, s64
    s_cselect_b32 s21, s63, s65
    s_mov_b32 s22, 1835008
    v_lshrrev_b32 v28, 2, v1
    v_mul_u32_u24 v28, 3584, v28
    v_and_b32 v29, 3, v1
    v_lshl_add_u32 v28, v29, 7, v28
    s_mul_i32 s46, s46, 57344
    s_mul_i32 s47, s47, 448
L_WU2:
    s_add_u32 s46, s46, s47
    buffer_load_dword v25, v28, s[20:23], s46 offen
    s_branch L_WU3
L_WU4:
    global_load_dword v25, v2, s[60:61]
L_WU3:
    s_call_b64 s[58:59], L_BODY
    s_mov_b32 s20, s60
    s_and_b32 s21, s61, 0xffff
    s_mov_b32 s22, 1024
    s_mov_b32 s23, 0x00020000
    s_and_b32 s46, s38, 1
    s_lshl_b32 s46, s46, 9
    s_lshl_b32 s47, s36, 6
    s_add_u32 s46, s46, s47
    s_lshr_b32 s55, s53, 1
    s_lshl_b32 s54, s55, 4
    s_lshl_b32 s55, s55, 14
    s_add_u32 s55, s55, s46
    v_and_b32 v105, 48, v1
    v_and_b32 v104, 15, v1
    v_lshl_add_u32 v104, v104, 10, v105
    buffer_load_dwordx4 v[96:99], v104, s[16:19], s55 offen
    buffer_load_dwordx4 v[100:103], v105, s[20:23], s46 offen
    s_call_b64 s[58:59], L_BODY
    s_cmp_eq_u32 s36, 6
    s_cbranch_scc0 L_NC2
    v_lshlrev_b32 v30, 7, v1
    v_add_u32 v30, 4931588, v30
    global_load_dword v31, v30, s[72:73] sc1
L_NC2:
    s_call_b64 s[58:59], L_BODY
    s_cmp_eq_u32 s36, 6
    s_cbranch_scc0 L_C2_OUT
    s_mov_b32 s39, 20000
    s_waitcnt vmcnt(0)
L_C2_POLL:
    v_cmp_gt_u32 vcc, 16, v31
    s_sub_u32 s39, s39, 1
    s_cbranch_scc1 L_C2_OK
    s_cbranch_vccz L_C2_OK
    s_sleep 8
    global_load_dword v31, v30, s[72:73] sc1
    s_waitcnt vmcnt(0)
    s_branch L_C2_POLL
L_C2_OK:
    v_mov_b32 v30, 159952
    ds_write_b32 v30, v30
L_C2_OUT:
    s_call_b64 s[58:59], L_BODY
    s_call_b64 s[58:59], L_BODY
    s_mov_b32 s32, s14
    s_mov_b32 s33, s15
    s_add_u32 m0, s43, 141440
    s_add_u32 s48, s45, 0
    s_add_u32 s48, s48, 0
    buffer_load_dwordx4 v24, s[32:35], s48 offen lds
    s_mov_b32 s32, s14
    s_mov_b32 s33, s15
    s_add_u32 m0, s43, 142464
    s_add_u32 s48, s45, 0
    s_add_u32 s48, s48, s40
    buffer_load_dwordx4 v24, s[32:35], s48 offen lds
    s_call_b64 s[58:59], L_BODY
    s_mov_b32 s32, s12
    s_mov_b32 s33, s13
    s_add_u32 m0, s43, 149632
    s_add_u32 s48, s45, s41
    s_add_u32 s48, s48, 0
    buffer_load_dwordx4 v24, s[32:35], s48 offen lds
    s_mov_b32 s32, s12
    s_mov_b32 s33, s13
    s_add_u32 m0, s43, 150656
    s_add_u32 s48, s45, s41
    s_add_u32 s48, s48, s40
    buffer_load_dwordx4 v24, s[32:35], s48 offen lds
    s_call_b64 s[58:59], L_BODY
    s_call_b64 s[58:59], L_BODY
    s_branch L_DONE
L_RETRY:
    s_mov_b32 s44, 1
    v_add_u32 v21, 5005312, v2
    v_mov_b32 v28, 0xff800000
    s_mov_b32 s47, 0
L_RMAX:
    buffer_load_dwordx4 v[8:11], v21, s[28:31], s47 offen sc1
    s_add_u32 s47, s47, 2048
    s_waitcnt vmcnt(0)
    v_mfma_f32_32x32x16_bf16 v[48:63], v[8:11], v[108:111], 0
    s_nop 11
    v_max3_f32 v28, v28, v48, v49
    v_max3_f32 v28, v28, v50, v51
    v_max3_f32 v28, v28, v52, v53
    v_max3_f32 v28, v28, v54, v55
    v_max3_f32 v28, v28, v56, v57
    v_max3_f32 v28, v28, v58, v59
    v_max3_f32 v28, v28, v60, v61
    v_max3_f32 v28, v28, v62, v63
    s_cmp_lt_u32 s47, 0x20000
    s_cbranch_scc1 L_RMAX
    v_mov_b32 v29, v28
    s_nop 1
    v_permlane32_swap_b32 v28, v29
    v_max_f32 v28, v28, v29
    v_sub_f32 v32, 0, v28
    v_mov_b32 v33, v32
    v_mov_b32 v34, v32
    v_mov_b32 v35, v32
    v_mov_b32 v36, v32
    v_mov_b32 v37, v32
    v_mov_b32 v38, v32
    v_mov_b32 v39, v32
    v_mov_b32 v40, v32
    v_mov_b32 v41, v32
    v_mov_b32 v42, v32
    v_mov_b32 v43, v32
    v_mov_b32 v44, v32
    v_mov_b32 v45, v32
    v_mov_b32 v46, v32
    v_mov_b32 v47, v32
    v_mov_b32 v80, 0
    v_mov_b32 v81, 0
    v_mov_b32 v82, 0
    v_mov_b32 v83, 0
    v_mov_b32 v84, 0
    v_mov_b32 v85, 0
    v_mov_b32 v86, 0
    v_mov_b32 v87, 0
    v_mov_b32 v88, 0
    v_mov_b32 v89, 0
    v_mov_b32 v90, 0
    v_mov_b32 v91, 0
    v_mov_b32 v92, 0
    v_mov_b32 v93, 0
    v_mov_b32 v94, 0
    v_mov_b32 v95, 0
    v_cmp_eq_u32 vcc, 16, v27
    v_mov_b32 v28, 0x3f803f80
    v_mov_b32 v29, 0
    v_cndmask_b32 v28, v29, v28, vcc
    v_mov_b32 v12, v28
    v_mov_b32 v16, v28
    v_mov_b32 v13, v28
    v_mov_b32 v17, v28
    v_mov_b32 v14, v28
    v_mov_b32 v18, v28
    v_mov_b32 v15, v28
    v_mov_b32 v19, v28
    s_mov_b32 s47, 0
L_RLOOP:
    buffer_load_dwordx4 v[8:11], v21, s[28:31], s47 offen sc1
    s_mov_b32 exec_lo, 0xffff
    s_mov_b32 exec_hi, 0xffff
    buffer_load_dwordx4 v[12:15], v26, s[28:31], s47 offen sc1
    buffer_load_dwordx4 v[16:19], v26, s[28:31], s47 offen offset:512 sc1
    s_mov_b64 exec, -1
    s_add_u32 s47, s47, 2048
    s_waitcnt vmcnt(0)
    v_mfma_f32_32x32x16_bf16 v[48:63], v[8:11], v[108:111], v[32:47]
    s_nop 11
    v_exp_f32 v48, v48
    v_exp_f32 v49, v49
    v_exp_f32 v50, v50
    v_exp_f32 v51, v51
    v_exp_f32 v52, v52
    v_exp_f32 v53, v53
    v_exp_f32 v54, v54
    v_exp_f32 v55, v55
    v_exp_f32 v56, v56
    v_exp_f32 v57, v57
    v_exp_f32 v58, v58
    v_exp_f32 v59, v59
    v_exp_f32 v60, v60
    v_exp_f32 v61, v61
    v_exp_f32 v62, v62
    v_exp_f32 v63, v63
    s_nop 1
    v_smfmac_f32_32x32x32_bf16 v[80:95], v[12:15], v[48:55], v20
    v_smfmac_f32_32x32x32_bf16 v[80:95], v[16:19], v[56:63], v20
    s_cmp_lt_u32 s47, 0x20000
    s_cbranch_scc1 L_RLOOP
    s_branch L_FINISH
L_CODE_END:
.section .rodata,"a"
.p2align 6
.amdhsa_kernel sequential_preLN__grouped_kv_mqa__moe_arch_mod__prompt_kernel
  .amdhsa_next_free_vgpr 256
  .amdhsa_next_free_sgpr 74
  .amdhsa_accum_offset 256
  .amdhsa_group_segment_fixed_size 0
  .amdhsa_kernarg_size 104
  .amdhsa_user_sgpr_count 2
  .amdhsa_user_sgpr_kernarg_segment_ptr 1
  .amdhsa_system_sgpr_workgroup_id_x 1
.end_amdhsa_kernel
```
